```python
import torch

def _softmax(x, axis=-1):
    return torch.softmax(x, dim=axis)
def _gelu(x):
    return torch.nn.functional.gelu(x, approximate="tanh")
def _silu(x):
    return torch.nn.functional.silu(x)
def _sigmoid(x):
    return torch.sigmoid(x)
def _layernorm(x, axis=-1, eps=1e-5):
    m = x.mean(dim=axis, keepdim=True)
    v = x.var(dim=axis, keepdim=True, unbiased=False)
    return (x - m) / torch.sqrt(v + eps)
def _scatter_add(tgt, idx, src, axis=0):
    return tgt.clone().index_add_(axis, idx, src)
def _segment_sum(src, seg, n):
    out = torch.zeros((n,) + src.shape[1:], dtype=src.dtype)
    return out.index_add_(0, seg, src)
def _pad(x, pw):
    flat = tuple(v for pair in reversed(pw) for v in pair)
    return torch.nn.functional.pad(x, flat)

kernel_name = 'parallel_sum__ssm_conv_s5__dense_activation_squared_relu__prompt'

def setup_inputs():

    _w = (lambda a: (lambda t: t.to(torch.bfloat16) if t.is_floating_point() else t)(torch.as_tensor(a)))
    def _A_setup():
        B, S, D = 1, 2048, 512
        P = D
        Lambda_re = -0.5 * (lambda _x: torch.exp(torch.as_tensor(_x)))((lambda *s: torch.randn(*s, dtype=torch.bfloat16) * 0.8)(P))
        Lambda_im = (lambda *s: torch.randn(*s, dtype=torch.bfloat16) * 0.8)(P) * 1.0
        B_re = (lambda *s: torch.randn(*s, dtype=torch.bfloat16) * 0.8)(P, D) * (D ** -0.5)
        B_im = (lambda *s: torch.randn(*s, dtype=torch.bfloat16) * 0.8)(P, D) * (D ** -0.5)
        C_re = (lambda *s: torch.randn(*s, dtype=torch.bfloat16) * 0.8)(D, P) * (P ** -0.5)
        C_im = (lambda *s: torch.randn(*s, dtype=torch.bfloat16) * 0.8)(D, P) * (P ** -0.5)
        log_dt = (lambda *s: torch.randn(*s, dtype=torch.bfloat16) * 0.8)(P) * 0.3 - 2.0
        Dskip = (lambda *s: torch.randn(*s, dtype=torch.bfloat16) * 0.4)(D)
        return {
            "x": _w((lambda *s: torch.randn(*s, dtype=torch.bfloat16) * 0.05)(B, S, D)),
            "Lambda_re": _w(Lambda_re),
            "Lambda_im": _w(Lambda_im),
            "B_re": _w(B_re),
            "B_im": _w(B_im),
            "C_re": _w(C_re),
            "C_im": _w(C_im),
            "log_dt": _w(log_dt),
            "Dskip": _w(Dskip),
        }
    _A_in = _A_setup()

    def _B_setup():
        B, S, D, F = 1, 2048, 512, 1376
        return {
            "x": _w((lambda *s: torch.randn(*s, dtype=torch.bfloat16) * 0.05)(B, S, D)),
            "w1": _w((lambda *s: torch.randn(*s, dtype=torch.bfloat16) * 0.05)(D, F)),
            "b1": _w((lambda *s: torch.randn(*s, dtype=torch.bfloat16) * 0.2)(F)),
            "w2": _w((lambda *s: torch.randn(*s, dtype=torch.bfloat16) * 0.05)(F, D)),
            "b2": _w((lambda *s: torch.randn(*s, dtype=torch.bfloat16) * 0.8)(D)),
        }
    _B_in = _B_setup()

    return {
        "A_x": _A_in["x"],
        "A_Lambda_re": _A_in["Lambda_re"],
        "A_Lambda_im": _A_in["Lambda_im"],
        "A_B_re": _A_in["B_re"],
        "A_B_im": _A_in["B_im"],
        "A_C_re": _A_in["C_re"],
        "A_C_im": _A_in["C_im"],
        "A_log_dt": _A_in["log_dt"],
        "A_Dskip": _A_in["Dskip"],
        "B_x": _B_in["x"],
        "B_w1": _B_in["w1"],
        "B_b1": _B_in["b1"],
        "B_w2": _B_in["w2"],
        "B_b2": _B_in["b2"],
    }

def reference(A_x, A_Lambda_re, A_Lambda_im, A_B_re, A_B_im, A_C_re, A_C_im, A_log_dt, A_Dskip, B_x, B_w1, B_b1, B_w2, B_b2):
    def _A_ref(x, Lambda_re, Lambda_im, B_re, B_im, C_re, C_im, log_dt, Dskip):
        Bsz, L, H = x.shape
        Lam = Lambda_re + 1j * Lambda_im
        Bmat = B_re + 1j * B_im
        Cmat = C_re + 1j * C_im
        dt = torch.exp(log_dt)
        Lam_bar = torch.exp(dt * Lam)
        B_bar = ((Lam_bar - 1.0) / Lam)[:, None] * Bmat
        Bu = torch.einsum("bld,pd->blp", x + 0j, B_bar)
        h = torch.zeros_like(Bu[:, 0, :])
        hs = []
        for t in range(L):
            h = Lam_bar[None, :] * h + Bu[:, t, :]
            hs.append(h)
        hseq = torch.stack(hs, 1)
        y = 2.0 * torch.einsum("blp,dp->bld", hseq, Cmat).real + x * Dskip[None, None, :]
        return y

    def _B_ref(x, w1, b1, w2, b2):
        h = torch.einsum("bsd,df->bsf", x, w1) + b1
        zero = torch.zeros_like(h)
        r = torch.where(h > zero, h, zero)
        h = r * r
        out = torch.einsum("bsf,fd->bsd", h, w2) + b2
        return out

    x = A_x
    xn = _layernorm(x, axis=-1)
    return x + _A_ref(xn, A_Lambda_re, A_Lambda_im, A_B_re, A_B_im, A_C_re, A_C_im, A_log_dt, A_Dskip) + _B_ref(xn, B_w1, B_b1, B_w2, B_b2)
```

```asm
; @launch grid=(256,1,1) block=(256,1,1) lds=163840
.amdgcn_target "amdgcn-amd-amdhsa--gfx950"
.text
.globl parallel_sum__ssm_conv_s5__dense_activation_squared_relu__prompt_kernel
.p2align 8
.type parallel_sum__ssm_conv_s5__dense_activation_squared_relu__prompt_kernel,@function
parallel_sum__ssm_conv_s5__dense_activation_squared_relu__prompt_kernel:
  s_cmp_ge_u32 s2, 256
  s_cbranch_scc1 L_end
  s_load_dwordx2 s[40:41], s[0:1], 0
  s_load_dwordx2 s[44:45], s[0:1], 24
  s_load_dwordx2 s[48:49], s[0:1], 32
  s_load_dwordx2 s[52:53], s[0:1], 80
  v_lshrrev_b32 v180, 6, v0
  v_and_b32 v0, 63, v0
  s_lshr_b32 s88, s2, 3
  v_readfirstlane_b32 s76, v180
  s_getpc_b64 s[16:17]
L_pc:
  v_lshl_add_u32 v181, v180, 5, s88
  v_lshlrev_b32 v181, 10, v181
  v_lshl_add_u32 v181, v0, 4, v181
  v_min_u32 v181, L_end-L_pc-16, v181
  global_load_dwordx4 v[252:255], v181, s[16:17]
  s_and_b32 s77, s2, 1
  s_lshr_b32 s89, s2, 5
  s_lshl3_add_u32 s77, s77, s89
  s_lshr_b32 s89, s2, 6
  v_lshrrev_b32 v232, 3, v0
  v_lshrrev_b32 v182, 4, v0
  v_xor_b32 v233, v0, v182
  v_and_b32 v233, 7, v233
  v_lshlrev_b32 v233, 4, v233
  s_lshl2_add_u32 s90, s77, s76
  s_lshl_b32 s91, s90, 15
  v_lshrrev_b32 v160, 5, v0
  v_lshlrev_b32 v182, 4, v160
  v_and_or_b32 v182, v232, 3, v182
  v_lshl_add_u32 v182, v182, 10, v233
  v_add_u32 v2, s91, v182
  s_mul_i32 s82, s76, 24576
  s_mov_b32 s42, 2097152
  s_mov_b32 s43, 0x20000
  v_xor_b32 v3, 64, v2
  v_add_u32 v4, 6144, v2
  v_add_u32 v5, 9216, v3
  v_add_u32 v3, 3072, v3
  s_waitcnt lgkmcnt(0)
  s_add_u32 m0, s82, 0
  s_movk_i32 s98, 0
  buffer_load_dwordx4 v2, s[40:43], s98 offen offset:0  lds
  s_load_dwordx2 s[68:69], s[0:1], 128
  s_load_dwordx4 s[4:7], s[0:1], 8
  s_load_dwordx4 s[8:11], s[0:1], 56
  s_load_dwordx2 s[12:13], s[0:1], 88
  s_load_dwordx2 s[14:15], s[0:1], 104
  s_load_dwordx2 s[56:57], s[0:1], 40
  s_load_dwordx2 s[60:61], s[0:1], 48
  s_load_dwordx2 s[64:65], s[0:1], 96
  s_load_dwordx2 s[72:73], s[0:1], 112
  s_and_b32 s80, s88, 7
  s_and_b32 s78, s2, 6
  buffer_load_dwordx4 v3, s[40:43], s98 offen offset:1024  lds
  s_lshl_b32 s78, s78, 1
  s_and_b32 s92, s88, 3
  s_add_u32 s78, s78, s92
  s_and_b32 s79, s2, 7
  s_lshl2_add_u32 s79, s79, s89
  s_lshl2_add_u32 s92, s78, s76
  s_lshl_b32 s92, s92, 13
  s_and_b32 s93, s76, 1
  s_lshl_b32 s93, s93, 6
  v_xor_b32 v182, s93, v233
  v_lshl_add_u32 v182, v232, 10, v182
  v_add_u32 v6, s92, v182
  buffer_load_dwordx4 v4, s[40:43], s98 offen offset:2048  lds
  s_lshl_b32 s83, s76, 10
  s_add_u32 s83, s83, 98304
  s_mov_b32 s46, 524288
  s_mov_b32 s47, 0x20000
  s_mov_b32 s50, 524288
  s_mov_b32 s51, 0x20000
  s_mov_b32 s54, 1409024
  s_mov_b32 s55, 0x20000
  buffer_load_dwordx4 v5, s[40:43], s98 offen offset:3072  lds
  s_mul_i32 s81, s78, 43
  s_add_u32 s95, s81, 43
  s_lshr_b32 s81, s81, 4
  s_lshr_b32 s95, s95, 4
  s_sub_u32 s95, s95, s81
  s_mul_i32 s86, s76, 3072
  s_add_u32 s86, s86, 122880
  s_mul_i32 s92, s76, 192
  s_add_u32 m0, s83, 0
  s_mov_b32 s99, 0
  buffer_load_dwordx4 v6, s[44:47], s98 offen  lds
  s_lshl_b32 s94, s81, 6
  s_mov_b32 s87, 43691
  s_movk_i32 s88, 2560
  s_lshl_b32 s89, s95, 2
  v_bfrev_b32 v185, 1
  v_add_u32 v182, s92, v0
  v_lshl_add_u32 v186, v182, 4, s94
  s_add_u32 m0, s83, 4096
  s_nop 0
  buffer_load_dwordx4 v6, s[48:51], s98 offen  lds
  v_mul_u32_u24 v183, s87, v182
  v_lshrrev_b32 v183, 19, v183
  v_mad_i32_i24 v184, v183, -12, v182
  v_cmp_le_u32 vcc, s89, v184
  v_mad_u32_u24 v7, v183, s88, v186
  s_nop 0
  v_cndmask_b32 v7, v7, v185, vcc
  s_add_u32 m0, s86, 0
  s_nop 0
  buffer_load_dwordx4 v7, s[52:55], s99 offen offset:0  lds
  v_add_u32 v182, 64, v182
  v_mul_u32_u24 v183, s87, v182
  v_lshrrev_b32 v183, 19, v183
  v_mad_i32_i24 v184, v183, -12, v182
  v_cmp_le_u32 vcc, s89, v184
  v_mad_u32_u24 v8, v183, s88, v186
  s_nop 0
  v_cndmask_b32 v8, v8, v185, vcc
  buffer_load_dwordx4 v8, s[52:55], s99 offen offset:1024  lds
  v_add_u32 v182, 64, v182
  v_mul_u32_u24 v183, s87, v182
  v_lshrrev_b32 v183, 19, v183
  v_mad_i32_i24 v184, v183, -12, v182
  v_cmp_le_u32 vcc, s89, v184
  v_mad_u32_u24 v9, v183, s88, v186
  s_nop 0
  v_cndmask_b32 v9, v9, v185, vcc
  buffer_load_dwordx4 v9, s[52:55], s99 offen offset:2048  lds
  v_and_b32 v10, 31, v0
  v_lshl_add_u32 v239, v10, 1, s94
  s_lshl_b32 s92, s78, 6
  v_lshl_add_u32 v238, v10, 1, s92
  v_and_b32 v225, 7, v0
  v_lshrrev_b32 v226, 3, v0
  v_and_b32 v227, 1, v0
  s_lshl_b32 s92, s78, 4
  s_add_u32 s92, s92, s77
  s_lshl_b32 s92, s92, 11
  s_mul_i32 s93, s77, 11008
  s_lshl_b32 s94, s81, 6
  s_add_u32 s93, s93, s94
  s_lshl_b32 s94, s77, 4
  s_add_u32 s94, s94, s78
  s_lshl_b32 s94, s94, 13
  s_movk_i32 s35, 128
  s_movk_i32 s87, 1024
  s_mov_b32 s37, 0x03030303
  s_mov_b32 s22, 524288
  s_mov_b32 s26, 524288
  s_cmp_eq_u32 s76, 2
  s_cselect_b32 s87, 1376, s87
  s_cselect_b32 s35, 176128, s35
  s_cselect_b32 s88, s93, s92
  s_cselect_b32 s93, 1248, 0
  s_cselect_b32 s22, 1409024, s22
  s_cmp_eq_u32 s76, 3
  s_cselect_b32 s88, s94, s88
  s_cselect_b32 s22, 2097152, s22
  s_lshl_b32 s92, s2, 11
  s_mul_i32 s91, s2, 5504
  s_cmp_ge_u32 s76, 2
  s_cselect_b32 s91, s91, s92
  s_cselect_b32 s26, 1409024, s26
  s_cselect_b32 s37, -1, s37
  s_mov_b32 s23, 0x20000
  s_mov_b32 s27, 0x20000
  v_mul_u32_u24 v225, s87, v225
  v_mad_u32_u24 v225, v226, s35, v225
  v_mul_u32_u24 v227, s93, v227
  v_sub_u32 v225, v225, v227
  v_add_u32 v235, s88, v225
  v_lshlrev_b32 v225, 7, v0
  v_add_u32 v237, s91, v225
  s_waitcnt lgkmcnt(0)
  s_load_dword s84, s[68:69], 0
  s_cmp_eq_u32 s76, 0
  s_cselect_b64 s[20:21], s[44:45], s[48:49]
  s_cmp_eq_u32 s76, 2
  s_cselect_b64 s[20:21], s[52:53], s[20:21]
  s_cmp_eq_u32 s76, 3
  s_cselect_b64 s[20:21], s[40:41], s[20:21]
  s_cmp_eq_u32 s76, 0
  s_cselect_b64 s[24:25], s[56:57], s[60:61]
  s_cmp_ge_u32 s76, 2
  s_cselect_b64 s[24:25], s[64:65], s[24:25]
  s_and_b32 exec_lo, s37, 16776960
  s_and_b32 exec_hi, s37, 0
  buffer_load_dword v253, v235, s[20:23], 0 offen
  s_mov_b64 exec, -1
  global_load_ushort v220, v238, s[8:9]
  global_load_ushort v221, v238, s[4:5]
  global_load_ushort v222, v238, s[6:7]
  global_load_ushort v161, v239, s[12:13] offset:0
  global_load_ushort v174, v239, s[12:13] offset:64
  global_load_ushort v175, v239, s[12:13] offset:128
  s_add_u32 m0, s82, 4096
  s_movk_i32 s98, 128
  buffer_load_dwordx4 v2, s[40:43], s98 offen offset:0  lds
  s_mov_b32 s96, 0x3f803f80
  v_bfe_u32 v183, v0, 1, 3
  v_xor_b32 v183, v183, v160
  v_lshlrev_b32 v184, 7, v10
  v_bfe_u32 v191, v0, 2, 2
  v_lshl_add_u32 v191, v160, 3, v191
  v_mul_u32_u24 v191, 192, v191
  v_bfe_u32 v234, v0, 4, 1
  v_lshlrev_b32 v234, 5, v234
  v_and_b32 v193, 3, v0
  v_lshl_add_u32 v234, v193, 3, v234
  v_add_u32 v191, v191, v234
  s_add_u32 s92, s76, 0
  s_and_b32 s92, s92, 3
  s_lshl_b32 s93, s92, 1
  s_mul_i32 s92, s92, 3072
  s_add_u32 s92, s92, 122880
  v_xor_b32 v193, s93, v183
  buffer_load_dwordx4 v3, s[40:43], s98 offen offset:1024  lds
  v_lshl_add_u32 v193, v193, 4, v184
  v_add_u32 v144, s82, v193
  v_add_u32 v148, 98304, v193
  v_add_u32 v152, s92, v191
  s_add_u32 s92, s76, 1
  s_and_b32 s92, s92, 3
  s_lshl_b32 s93, s92, 1
  s_mul_i32 s92, s92, 3072
  s_add_u32 s92, s92, 122880
  v_xor_b32 v193, s93, v183
  v_lshl_add_u32 v193, v193, 4, v184
  v_add_u32 v145, s82, v193
  v_add_u32 v149, 98304, v193
  v_add_u32 v153, s92, v191
  s_add_u32 s92, s76, 2
  s_and_b32 s92, s92, 3
  s_lshl_b32 s93, s92, 1
  s_mul_i32 s92, s92, 3072
  buffer_load_dwordx4 v4, s[40:43], s98 offen offset:2048  lds
  s_add_u32 s92, s92, 122880
  v_xor_b32 v193, s93, v183
  v_lshl_add_u32 v193, v193, 4, v184
  v_add_u32 v146, s82, v193
  v_add_u32 v150, 98304, v193
  v_add_u32 v154, s92, v191
  s_add_u32 s92, s76, 3
  s_and_b32 s92, s92, 3
  s_lshl_b32 s93, s92, 1
  s_mul_i32 s92, s92, 3072
  s_add_u32 s92, s92, 122880
  v_xor_b32 v193, s93, v183
  v_lshl_add_u32 v193, v193, 4, v184
  v_add_u32 v147, s82, v193
  v_add_u32 v151, 98304, v193
  v_add_u32 v155, s92, v191
  v_lshrrev_b32 v193, 2, v0
  v_xor_b32 v193, v193, v0
  buffer_load_dwordx4 v5, s[40:43], s98 offen offset:3072  lds
  v_and_b32 v193, 4, v193
  v_cmp_eq_u32 vcc, 0, v193
  v_mov_b32 v194, s96
  s_mul_i32 s97, s90, 153728
  s_add_u32 s97, s97, 1048576
  v_cndmask_b32 v156, 0, v194, vcc
  v_mov_b32 v157, v156
  v_mov_b32 v158, v156
  v_mov_b32 v159, v156
  s_mov_b32 s70, 10887168
  s_mov_b32 s71, 0x20000
  s_mov_b32 s58, 524288
  s_mov_b32 s59, 0x20000
  s_mov_b32 s62, 524288
  s_mov_b32 s63, 0x20000
  s_mov_b32 s66, 1409024
  s_mov_b32 s67, 0x20000
  s_mov_b32 s74, 4194304
  s_add_u32 m0, s83, 8192
  s_mov_b32 s99, 176128
  buffer_load_dwordx4 v6, s[44:47], s98 offen  lds
  s_mov_b32 s75, 0x20000
  s_lshl4_add_u32 s93, s79, s76
  s_lshl_b32 s93, s93, 2
  v_lshrrev_b32 v193, 4, v0
  v_add_u32 v193, s93, v193
  v_and_b32 v194, 15, v0
  s_lshl_b32 s93, s80, 7
  v_lshl_add_u32 v194, v194, 3, s93
  v_lshl_add_u32 v224, v193, 10, v194
  global_load_dwordx2 a[248:249], v194, s[10:11]
  global_load_dwordx2 a[250:251], v194, s[14:15]
  s_lshl4_add_u32 s92, s77, s78
  s_lshl2_add_u32 s92, s92, s76
  s_lshl_b32 s92, s92, 1
  v_add_u32 v236, s92, v160
  v_lshlrev_b32 v228, 10, v236
  v_lshl_add_u32 v228, v10, 4, v228
  v_lshrrev_b32 v225, 2, v0
  s_add_u32 m0, s83, 12288
  s_nop 0
  buffer_load_dwordx4 v6, s[48:51], s98 offen  lds
  v_and_b32 v225, 4, v225
  v_xor_b32 v225, v0, v225
  v_and_b32 v225, 7, v225
  v_lshlrev_b32 v225, 4, v225
  v_lshl_add_u32 v225, v232, 10, v225
  s_mul_i32 s92, s76, 360448
  s_lshl_b32 s93, s80, 7
  s_add_u32 s92, s92, s93
  v_add_u32 v176, s92, v225
  v_add_u32 v177, 7168, v176
  v_add_u32 v178, 14336, v176
  v_add_u32 v179, 21504, v176
  v_bfe_u32 v225, v0, 2, 2
  v_lshl_add_u32 v225, v160, 2, v225
  v_lshl_add_u32 v225, v225, 7, v234
  v_lshlrev_b32 v226, 3, v0
  v_and_b32 v226, 64, v226
  v_xor_b32 v225, v225, v226
  s_add_u32 m0, s86, 12288
  s_nop 0
  buffer_load_dwordx4 v7, s[52:55], s99 offen offset:0  lds
  v_xor_b32 v226, 64, v225
  v_add_u32 v12, s82, v225
  v_add_u32 v13, s82, v226
  s_lshl_b32 s36, s76, 12
  s_add_u32 s36, s36, 98304
  v_lshrrev_b32 v225, 3, v10
  v_lshlrev_b32 v225, 2, v225
  v_and_or_b32 v225, v10, 3, v225
  v_and_b32 v226, 4, v10
  v_lshl_add_u32 v225, v226, 2, v225
  s_lshl_b32 s92, s90, 9
  s_add_u32 s92, s92, 327680
  v_lshl_add_u32 v14, v225, 4, s92
  s_lshl_b32 s92, s76, 7
  s_add_u32 s92, s92, 150016
  v_lshl_add_u32 v15, v225, 2, s92
  v_lshl_add_u32 v229, v160, 6, s92
  v_lshlrev_b32 v236, 4, v236
  buffer_load_dwordx4 v8, s[52:55], s99 offen offset:1024  lds
  v_add_u32 v236, 327680, v236
  v_mov_b32 v181, 0
  v_mov_b32 v182, 0
  v_mov_b32 v183, 0
  v_mov_b32 v185, 0
  v_mov_b32 v186, 0
  v_mov_b32 v187, 0
  v_mov_b32 v190, 0
  v_mov_b32 v191, 0
  v_mov_b32 v194, 0
  v_mov_b32 v195, 0
  v_mov_b32 v198, 0
  v_mov_b32 v199, 0
  s_lshl_b32 s92, s76, 1
  s_cmp_gt_u32 s92, 0
  s_cselect_b32 s4, -1, 0
  s_cmp_ge_u32 s92, 0
  s_cselect_b32 s5, -1, 0
  s_cmp_gt_u32 s92, 1
  s_cselect_b32 s6, -1, 0
  s_cmp_ge_u32 s92, 1
  s_cselect_b32 s7, -1, 0
  buffer_load_dwordx4 v9, s[52:55], s99 offen offset:2048  lds
  s_cmp_gt_u32 s92, 2
  s_cselect_b32 s8, -1, 0
  s_cmp_ge_u32 s92, 2
  s_cselect_b32 s9, -1, 0
  s_cmp_gt_u32 s92, 3
  s_cselect_b32 s12, -1, 0
  s_cmp_ge_u32 s92, 3
  s_cselect_b32 s13, -1, 0
  s_cmp_gt_u32 s92, 4
  s_cselect_b32 s16, -1, 0
  s_cmp_ge_u32 s92, 4
  s_cselect_b32 s17, -1, 0
  s_cmp_gt_u32 s92, 5
  s_cselect_b32 s28, -1, 0
  s_cmp_ge_u32 s92, 5
  s_cselect_b32 s29, -1, 0
  s_cmp_gt_u32 s92, 6
  s_cselect_b32 s30, -1, 0
  s_cmp_ge_u32 s92, 6
  s_cselect_b32 s31, -1, 0
  s_lshl_b32 s92, s81, 11
  s_add_u32 s92, s92, s97
  s_add_u32 s32, s92, 0
  s_cmp_gt_u32 s95, 0
  s_cselect_b32 s32, s32, 0x80000000
  s_add_u32 s33, s92, 2048
  s_cmp_gt_u32 s95, 1
  s_cselect_b32 s33, s33, 0x80000000
  s_add_u32 s34, s92, 4096
  s_cmp_gt_u32 s95, 2
  s_cselect_b32 s34, s34, 0x80000000
  s_waitcnt lgkmcnt(0)
  s_add_u32 s84, s84, 1
  s_xor_b32 s85, s84, 0x5bd1e995
  s_waitcnt vmcnt(18)
  s_barrier
  ds_read_b128 v[96:99], v144 offset:0
  ds_read_b128 v[100:103], v148 offset:0
  ds_read_b128 v[104:107], v148 offset:4096
  ds_read_b64_tr_b16 v[108:109], v152 offset:0
  ds_read_b64_tr_b16 v[110:111], v152 offset:768
  ds_read_b64_tr_b16 v[112:113], v152 offset:64
  ds_read_b64_tr_b16 v[114:115], v152 offset:832
  ds_read_b64_tr_b16 v[116:117], v152 offset:128
  ds_read_b64_tr_b16 v[118:119], v152 offset:896
  s_waitcnt lgkmcnt(4)
  v_mfma_f32_32x32x16_bf16 v[16:31], v[96:99], v[100:103], 0
  ds_read_b128 v[120:123], v145 offset:0
  ds_read_b128 v[124:127], v149 offset:0
  ds_read_b128 v[128:131], v149 offset:4096
  v_mfma_f32_16x16x32_bf16 v[200:203], v[156:159], v[100:103], 0
  v_mfma_f32_32x32x16_bf16 v[32:47], v[96:99], v[104:107], 0
  ds_read_b64_tr_b16 v[132:133], v153 offset:0
  ds_read_b64_tr_b16 v[134:135], v153 offset:768
  s_add_u32 m0, s82, 8192
  s_movk_i32 s98, 256
  buffer_load_dwordx4 v2, s[40:43], s98 offen offset:0  lds
  v_mfma_f32_16x16x32_bf16 v[204:207], v[156:159], v[104:107], 0
  v_mfma_f32_32x32x16_bf16 v[48:63], v[108:111], v[96:99], 0
  ds_read_b64_tr_b16 v[136:137], v153 offset:64
  ds_read_b64_tr_b16 v[138:139], v153 offset:832
  buffer_load_dwordx4 v3, s[40:43], s98 offen offset:1024  lds
  s_waitcnt lgkmcnt(7)
  v_mfma_f32_32x32x16_bf16 v[64:79], v[112:115], v[96:99], 0
  ds_read_b64_tr_b16 v[140:141], v153 offset:128
  ds_read_b64_tr_b16 v[142:143], v153 offset:896
  buffer_load_dwordx4 v4, s[40:43], s98 offen offset:2048  lds
  v_mfma_f32_32x32x16_bf16 v[80:95], v[116:119], v[96:99], 0
  buffer_load_dwordx4 v5, s[40:43], s98 offen offset:3072  lds
  s_waitcnt lgkmcnt(4)
  v_mfma_f32_32x32x16_bf16 v[16:31], v[120:123], v[124:127], v[16:31]
  ds_read_b128 v[96:99], v146 offset:0
  ds_read_b128 v[100:103], v150 offset:0
  ds_read_b128 v[104:107], v150 offset:4096
  v_mfma_f32_32x32x16_bf16 v[32:47], v[120:123], v[128:131], v[32:47]
  ds_read_b64_tr_b16 v[108:109], v154 offset:0
  ds_read_b64_tr_b16 v[110:111], v154 offset:768
  s_add_u32 m0, s83, 16384
  s_mov_b32 s99, 352256
  buffer_load_dwordx4 v6, s[44:47], s98 offen  lds
  v_mfma_f32_32x32x16_bf16 v[48:63], v[132:135], v[120:123], v[48:63]
  ds_read_b64_tr_b16 v[112:113], v154 offset:64
  ds_read_b64_tr_b16 v[114:115], v154 offset:832
  s_add_u32 m0, s83, 20480
  s_nop 0
  buffer_load_dwordx4 v6, s[48:51], s98 offen  lds
  v_mfma_f32_16x16x32_bf16 v[208:211], v[156:159], v[132:135], 0
  s_waitcnt lgkmcnt(7)
  v_mfma_f32_32x32x16_bf16 v[64:79], v[136:139], v[120:123], v[64:79]
  ds_read_b64_tr_b16 v[116:117], v154 offset:128
  ds_read_b64_tr_b16 v[118:119], v154 offset:896
  s_add_u32 m0, s86, 24576
  s_nop 0
  buffer_load_dwordx4 v7, s[52:55], s99 offen offset:0  lds
  v_mfma_f32_32x32x16_bf16 v[80:95], v[140:143], v[120:123], v[80:95]
  buffer_load_dwordx4 v8, s[52:55], s99 offen offset:1024  lds
  s_waitcnt lgkmcnt(4)
  v_mfma_f32_32x32x16_bf16 v[16:31], v[96:99], v[100:103], v[16:31]
  ds_read_b128 v[120:123], v147 offset:0
  ds_read_b128 v[124:127], v151 offset:0
  ds_read_b128 v[128:131], v151 offset:4096
  s_waitcnt vmcnt(19)
  v_mfma_f32_32x32x16_bf16 v[32:47], v[96:99], v[104:107], v[32:47]
  ds_read_b64_tr_b16 v[132:133], v155 offset:0
  ds_read_b64_tr_b16 v[134:135], v155 offset:768
  buffer_load_dwordx4 v9, s[52:55], s99 offen offset:2048  lds
  v_lshlrev_b32_e64 v220, 16, v220
  v_mfma_f32_32x32x16_bf16 v[48:63], v[108:111], v[96:99], v[48:63]
  ds_read_b64_tr_b16 v[136:137], v155 offset:64
  ds_read_b64_tr_b16 v[138:139], v155 offset:832
  buffer_load_dwordx4 v[240:243], v228, s[40:43], 0 offen
  v_lshlrev_b32 v221, 16, v221
  s_waitcnt lgkmcnt(7)
  v_mfma_f32_32x32x16_bf16 v[64:79], v[112:115], v[96:99], v[64:79]
  ds_read_b64_tr_b16 v[140:141], v155 offset:128
  ds_read_b64_tr_b16 v[142:143], v155 offset:896
  buffer_load_dwordx4 v[244:247], v228, s[40:43], 0 offen offset:512
  v_lshlrev_b32_e64 v222, 16, v222
  v_mfma_f32_16x16x32_bf16 v[212:215], v[156:159], v[112:115], 0
  v_mfma_f32_32x32x16_bf16 v[80:95], v[116:119], v[96:99], v[80:95]
  s_cmp_eq_u32 s76, 3
  s_cbranch_scc1 L_nox3
  s_and_b32 exec_lo, s37, 4278190080
  s_and_b32 exec_hi, s37, 4294967295
  buffer_load_dword v253, v235, s[20:23], 0 offen
L_nox3:
  s_mov_b64 exec, -1
  v_mul_f32 v220, 0x3fb8aa3b, v220
  s_waitcnt lgkmcnt(0)
  v_mfma_f32_32x32x16_bf16 v[16:31], v[120:123], v[124:127], v[16:31]
  s_waitcnt vmcnt(11)
  s_barrier
  ds_read_b128 v[96:99], v144 offset:4096
  ds_read_b128 v[100:103], v148 offset:8192
  ds_read_b128 v[104:107], v148 offset:12288
  v_exp_f32 v220, v220
  v_mfma_f32_32x32x16_bf16 v[32:47], v[120:123], v[128:131], v[32:47]
  ds_read_b64_tr_b16 v[108:109], v152 offset:12288
  ds_read_b64_tr_b16 v[110:111], v152 offset:13056
  s_add_u32 m0, s82, 0
  s_movk_i32 s98, 384
  buffer_load_dwordx4 v2, s[40:43], s98 offen offset:0  lds
  v_mov_b32_e64 v189, v161
  v_mfma_f32_32x32x16_bf16 v[48:63], v[132:135], v[120:123], v[48:63]
  ds_read_b64_tr_b16 v[112:113], v152 offset:12352
  ds_read_b64_tr_b16 v[114:115], v152 offset:13120
  v_mov_b32_e64 v193, v174
  v_mfma_f32_32x32x16_bf16 v[64:79], v[136:139], v[120:123], v[64:79]
  ds_read_b64_tr_b16 v[116:117], v152 offset:12416
  ds_read_b64_tr_b16 v[118:119], v152 offset:13184
  buffer_load_dwordx4 v3, s[40:43], s98 offen offset:1024  lds
  v_mov_b32_e64 v197, v175
  v_mfma_f32_32x32x16_bf16 v[80:95], v[140:143], v[120:123], v[80:95]
  v_cvt_pk_bf16_f32 v220, v220, v220
  v_mfma_f32_16x16x32_bf16 v[216:219], v[156:159], v[140:143], 0
  s_waitcnt lgkmcnt(4)
  v_mfma_f32_32x32x16_bf16 v[16:31], v[96:99], v[100:103], v[16:31]
  ds_read_b128 v[120:123], v145 offset:4096
  ds_read_b128 v[124:127], v149 offset:8192
  ds_read_b128 v[128:131], v149 offset:12288
  v_and_b32 v220, 0xffff0000, v220
  v_mfma_f32_16x16x32_bf16 v[200:203], v[156:159], v[100:103], v[200:203]
  v_mfma_f32_32x32x16_bf16 v[32:47], v[96:99], v[104:107], v[32:47]
  ds_read_b64_tr_b16 v[132:133], v153 offset:12288
  ds_read_b64_tr_b16 v[134:135], v153 offset:13056
  buffer_load_dwordx4 v4, s[40:43], s98 offen offset:2048  lds
  v_mul_f32 v170, v220, v221
  v_mfma_f32_16x16x32_bf16 v[204:207], v[156:159], v[104:107], v[204:207]
  v_mfma_f32_32x32x16_bf16 v[48:63], v[108:111], v[96:99], v[48:63]
  ds_read_b64_tr_b16 v[136:137], v153 offset:12352
  ds_read_b64_tr_b16 v[138:139], v153 offset:13120
  v_mul_f32 v171, v220, v222
  s_waitcnt lgkmcnt(7)
  v_mfma_f32_32x32x16_bf16 v[64:79], v[112:115], v[96:99], v[64:79]
  ds_read_b64_tr_b16 v[140:141], v153 offset:12416
  ds_read_b64_tr_b16 v[142:143], v153 offset:13184
  buffer_load_dwordx4 v5, s[40:43], s98 offen offset:3072  lds
  v_mul_f32 v170, 0x3fb8aa3b, v170
  v_mfma_f32_32x32x16_bf16 v[80:95], v[116:119], v[96:99], v[80:95]
  v_mul_f32 v171, 0.15915494, v171
  s_waitcnt lgkmcnt(4)
  v_mfma_f32_32x32x16_bf16 v[16:31], v[120:123], v[124:127], v[16:31]
  ds_read_b128 v[96:99], v146 offset:4096
  ds_read_b128 v[100:103], v150 offset:8192
  ds_read_b128 v[104:107], v150 offset:12288
  v_rndne_f32 v225, v171
  v_mfma_f32_32x32x16_bf16 v[32:47], v[120:123], v[128:131], v[32:47]
  ds_read_b64_tr_b16 v[108:109], v154 offset:12288
  ds_read_b64_tr_b16 v[110:111], v154 offset:13056
  s_add_u32 m0, s83, 0
  s_mov_b32 s99, 528384
  buffer_load_dwordx4 v6, s[44:47], s98 offen  lds
  v_sub_f32_e64 v171, v171, v225
  v_mfma_f32_32x32x16_bf16 v[48:63], v[132:135], v[120:123], v[48:63]
  ds_read_b64_tr_b16 v[112:113], v154 offset:12352
  ds_read_b64_tr_b16 v[114:115], v154 offset:13120
  v_exp_f32_e64 v225, v170
  v_mfma_f32_16x16x32_bf16 v[208:211], v[156:159], v[132:135], v[208:211]
  s_waitcnt lgkmcnt(7)
  v_mfma_f32_32x32x16_bf16 v[64:79], v[136:139], v[120:123], v[64:79]
  ds_read_b64_tr_b16 v[116:117], v154 offset:12416
  ds_read_b64_tr_b16 v[118:119], v154 offset:13184
  s_add_u32 m0, s83, 4096
  s_nop 0
  buffer_load_dwordx4 v6, s[48:51], s98 offen  lds
  v_fract_f32_e64 v226, v171
  v_mfma_f32_32x32x16_bf16 v[80:95], v[140:143], v[120:123], v[80:95]
  v_cos_f32 v162, v226
  s_waitcnt lgkmcnt(4)
  v_mfma_f32_32x32x16_bf16 v[16:31], v[96:99], v[100:103], v[16:31]
  ds_read_b128 v[120:123], v147 offset:4096
  ds_read_b128 v[124:127], v151 offset:8192
  ds_read_b128 v[128:131], v151 offset:12288
  v_sin_f32_e64 v163, v226
  v_mfma_f32_32x32x16_bf16 v[32:47], v[96:99], v[104:107], v[32:47]
  ds_read_b64_tr_b16 v[132:133], v155 offset:12288
  ds_read_b64_tr_b16 v[134:135], v155 offset:13056
  s_add_u32 m0, s86, 0
  s_nop 0
  buffer_load_dwordx4 v7, s[52:55], s99 offen offset:0  lds
  v_mul_f32_e64 v162, v162, v225
  v_mfma_f32_32x32x16_bf16 v[48:63], v[108:111], v[96:99], v[48:63]
  ds_read_b64_tr_b16 v[136:137], v155 offset:12352
  ds_read_b64_tr_b16 v[138:139], v155 offset:13120
  v_mul_f32 v163, v163, v225
  s_waitcnt lgkmcnt(7)
  v_mfma_f32_32x32x16_bf16 v[64:79], v[112:115], v[96:99], v[64:79]
  ds_read_b64_tr_b16 v[140:141], v155 offset:12416
  ds_read_b64_tr_b16 v[142:143], v155 offset:13184
  buffer_load_dwordx4 v8, s[52:55], s99 offen offset:1024  lds
  v_mul_f32 v225, 0x41800000, v170
  v_mfma_f32_16x16x32_bf16 v[212:215], v[156:159], v[112:115], v[212:215]
  v_mfma_f32_32x32x16_bf16 v[80:95], v[116:119], v[96:99], v[80:95]
  buffer_load_dwordx4 v9, s[52:55], s99 offen offset:2048  lds
  v_mul_f32 v226, 0x41800000, v171
  s_waitcnt lgkmcnt(0)
  v_mfma_f32_32x32x16_bf16 v[16:31], v[120:123], v[124:127], v[16:31]
  s_waitcnt vmcnt(11)
  s_barrier
  ds_read_b128 v[96:99], v144 offset:8192
  ds_read_b128 v[100:103], v148 offset:16384
  ds_read_b128 v[104:107], v148 offset:20480
  v_exp_f32 v225, v225
  v_mfma_f32_32x32x16_bf16 v[32:47], v[120:123], v[128:131], v[32:47]
  ds_read_b64_tr_b16 v[108:109], v152 offset:24576
  ds_read_b64_tr_b16 v[110:111], v152 offset:25344
  s_add_u32 m0, s82, 4096
  s_movk_i32 s98, 512
  buffer_load_dwordx4 v2, s[40:43], s98 offen offset:0  lds
  v_fract_f32 v226, v226
  v_mfma_f32_32x32x16_bf16 v[48:63], v[132:135], v[120:123], v[48:63]
  ds_read_b64_tr_b16 v[112:113], v152 offset:24640
  ds_read_b64_tr_b16 v[114:115], v152 offset:25408
  v_cos_f32_e64 v164, v226
  v_mfma_f32_32x32x16_bf16 v[64:79], v[136:139], v[120:123], v[64:79]
  ds_read_b64_tr_b16 v[116:117], v152 offset:24704
  ds_read_b64_tr_b16 v[118:119], v152 offset:25472
  buffer_load_dwordx4 v3, s[40:43], s98 offen offset:1024  lds
  v_sin_f32_e64 v165, v226
  v_mfma_f32_32x32x16_bf16 v[80:95], v[140:143], v[120:123], v[80:95]
  v_mul_f32_e64 v164, v164, v225
  v_mfma_f32_16x16x32_bf16 v[216:219], v[156:159], v[140:143], v[216:219]
  s_waitcnt lgkmcnt(4)
  v_mfma_f32_32x32x16_bf16 v[16:31], v[96:99], v[100:103], v[16:31]
  ds_read_b128 v[120:123], v145 offset:8192
  ds_read_b128 v[124:127], v149 offset:16384
  ds_read_b128 v[128:131], v149 offset:20480
  v_mul_f32 v165, v165, v225
  v_mfma_f32_16x16x32_bf16 v[200:203], v[156:159], v[100:103], v[200:203]
  v_mfma_f32_32x32x16_bf16 v[32:47], v[96:99], v[104:107], v[32:47]
  ds_read_b64_tr_b16 v[132:133], v153 offset:24576
  ds_read_b64_tr_b16 v[134:135], v153 offset:25344
  buffer_load_dwordx4 v4, s[40:43], s98 offen offset:2048  lds
  v_add_f32_e64 v225, -1.0, v162
  v_mfma_f32_16x16x32_bf16 v[204:207], v[156:159], v[104:107], v[204:207]
  v_mfma_f32_32x32x16_bf16 v[48:63], v[108:111], v[96:99], v[48:63]
  ds_read_b64_tr_b16 v[136:137], v153 offset:24640
  ds_read_b64_tr_b16 v[138:139], v153 offset:25408
  v_mul_f32 v226, v221, v221
  s_waitcnt lgkmcnt(7)
  v_mfma_f32_32x32x16_bf16 v[64:79], v[112:115], v[96:99], v[64:79]
  ds_read_b64_tr_b16 v[140:141], v153 offset:24704
  ds_read_b64_tr_b16 v[142:143], v153 offset:25472
  buffer_load_dwordx4 v5, s[40:43], s98 offen offset:3072  lds
  v_fma_f32 v226, v222, v222, v226
  v_mfma_f32_32x32x16_bf16 v[80:95], v[116:119], v[96:99], v[80:95]
  v_rcp_f32 v226, v226
  s_waitcnt lgkmcnt(4)
  v_mfma_f32_32x32x16_bf16 v[16:31], v[120:123], v[124:127], v[16:31]
  ds_read_b128 v[96:99], v146 offset:8192
  ds_read_b128 v[100:103], v150 offset:16384
  ds_read_b128 v[104:107], v150 offset:20480
  v_mul_f32_e64 v168, v225, v221
  v_mfma_f32_32x32x16_bf16 v[32:47], v[120:123], v[128:131], v[32:47]
  ds_read_b64_tr_b16 v[108:109], v154 offset:24576
  ds_read_b64_tr_b16 v[110:111], v154 offset:25344
  s_add_u32 m0, s83, 8192
  s_mov_b32 s99, 704512
  buffer_load_dwordx4 v6, s[44:47], s98 offen  lds
  v_fma_f32 v168, v163, v222, v168
  v_mfma_f32_32x32x16_bf16 v[48:63], v[132:135], v[120:123], v[48:63]
  ds_read_b64_tr_b16 v[112:113], v154 offset:24640
  ds_read_b64_tr_b16 v[114:115], v154 offset:25408
  v_mul_f32_e64 v169, v163, v221
  v_mfma_f32_16x16x32_bf16 v[208:211], v[156:159], v[132:135], v[208:211]
  s_waitcnt lgkmcnt(7)
  v_mfma_f32_32x32x16_bf16 v[64:79], v[136:139], v[120:123], v[64:79]
  ds_read_b64_tr_b16 v[116:117], v154 offset:24704
  ds_read_b64_tr_b16 v[118:119], v154 offset:25472
  s_add_u32 m0, s83, 12288
  s_nop 0
  buffer_load_dwordx4 v6, s[48:51], s98 offen  lds
  v_fma_f32 v169, -v225, v222, v169
  v_mfma_f32_32x32x16_bf16 v[80:95], v[140:143], v[120:123], v[80:95]
  v_add_f32 v226, v226, v226
  s_waitcnt lgkmcnt(4)
  v_mfma_f32_32x32x16_bf16 v[16:31], v[96:99], v[100:103], v[16:31]
  ds_read_b128 v[120:123], v147 offset:8192
  ds_read_b128 v[124:127], v151 offset:16384
  ds_read_b128 v[128:131], v151 offset:20480
  s_waitcnt vmcnt(15)
  v_mfma_f32_32x32x16_bf16 v[32:47], v[96:99], v[104:107], v[32:47]
  ds_read_b64_tr_b16 v[132:133], v155 offset:24576
  ds_read_b64_tr_b16 v[134:135], v155 offset:25344
  s_add_u32 m0, s86, 12288
  s_nop 0
  buffer_load_dwordx4 v7, s[52:55], s99 offen offset:0  lds
  v_mov_b32 v230, 0
  v_mov_b32 v231, 0
  v_mfma_f32_32x32x16_bf16 v[48:63], v[108:111], v[96:99], v[48:63]
  ds_read_b64_tr_b16 v[136:137], v155 offset:24640
  ds_read_b64_tr_b16 v[138:139], v155 offset:25408
  v_dot2c_f32_bf16 v230, s96, v240
  v_dot2c_f32_bf16 v231, v240, v240
  s_waitcnt lgkmcnt(7)
  v_mfma_f32_32x32x16_bf16 v[64:79], v[112:115], v[96:99], v[64:79]
  ds_read_b64_tr_b16 v[140:141], v155 offset:24704
  ds_read_b64_tr_b16 v[142:143], v155 offset:25472
  buffer_load_dwordx4 v8, s[52:55], s99 offen offset:1024  lds
  v_dot2c_f32_bf16 v230, s96, v241
  v_dot2c_f32_bf16 v231, v241, v241
  v_mfma_f32_16x16x32_bf16 v[212:215], v[156:159], v[112:115], v[212:215]
  v_mfma_f32_32x32x16_bf16 v[80:95], v[116:119], v[96:99], v[80:95]
  buffer_load_dwordx4 v9, s[52:55], s99 offen offset:2048  lds
  v_dot2c_f32_bf16 v230, s96, v242
  v_dot2c_f32_bf16 v231, v242, v242
  s_waitcnt lgkmcnt(0)
  v_mfma_f32_32x32x16_bf16 v[16:31], v[120:123], v[124:127], v[16:31]
  s_waitcnt vmcnt(9)
  s_barrier
  ds_read_b128 v[96:99], v144 offset:0
  ds_read_b128 v[100:103], v148 offset:0
  ds_read_b128 v[104:107], v148 offset:4096
  v_dot2c_f32_bf16 v230, s96, v243
  v_mfma_f32_32x32x16_bf16 v[32:47], v[120:123], v[128:131], v[32:47]
  ds_read_b64_tr_b16 v[108:109], v152 offset:0
  ds_read_b64_tr_b16 v[110:111], v152 offset:768
  s_add_u32 m0, s82, 8192
  s_movk_i32 s98, 640
  buffer_load_dwordx4 v2, s[40:43], s98 offen offset:0  lds
  v_dot2c_f32_bf16 v231, v243, v243
  v_dot2c_f32_bf16 v230, s96, v244
  v_mfma_f32_32x32x16_bf16 v[48:63], v[132:135], v[120:123], v[48:63]
  ds_read_b64_tr_b16 v[112:113], v152 offset:64
  ds_read_b64_tr_b16 v[114:115], v152 offset:832
  v_dot2c_f32_bf16 v231, v244, v244
  v_dot2c_f32_bf16 v230, s96, v245
  v_mfma_f32_32x32x16_bf16 v[64:79], v[136:139], v[120:123], v[64:79]
  ds_read_b64_tr_b16 v[116:117], v152 offset:128
  ds_read_b64_tr_b16 v[118:119], v152 offset:896
  buffer_load_dwordx4 v3, s[40:43], s98 offen offset:1024  lds
  v_dot2c_f32_bf16 v231, v245, v245
  v_dot2c_f32_bf16 v230, s96, v246
  v_mfma_f32_32x32x16_bf16 v[80:95], v[140:143], v[120:123], v[80:95]
  v_dot2c_f32_bf16 v231, v246, v246
  v_dot2c_f32_bf16 v230, s96, v247
  v_mfma_f32_16x16x32_bf16 v[216:219], v[156:159], v[140:143], v[216:219]
  s_waitcnt lgkmcnt(4)
  v_mfma_f32_32x32x16_bf16 v[16:31], v[96:99], v[100:103], v[16:31]
  ds_read_b128 v[120:123], v145 offset:0
  ds_read_b128 v[124:127], v149 offset:0
  ds_read_b128 v[128:131], v149 offset:4096
  v_dot2c_f32_bf16 v231, v247, v247
  v_mfma_f32_16x16x32_bf16 v[200:203], v[156:159], v[100:103], v[200:203]
  v_mfma_f32_32x32x16_bf16 v[32:47], v[96:99], v[104:107], v[32:47]
  ds_read_b64_tr_b16 v[132:133], v153 offset:0
  ds_read_b64_tr_b16 v[134:135], v153 offset:768
  buffer_load_dwordx4 v4, s[40:43], s98 offen offset:2048  lds
  v_add_f32_dpp v230, v230, v230 row_shr:1 row_mask:0xf bank_mask:0xf bound_ctrl:0
  v_add_f32_dpp v231, v231, v231 row_shr:1 row_mask:0xf bank_mask:0xf bound_ctrl:0
  v_mfma_f32_16x16x32_bf16 v[204:207], v[156:159], v[104:107], v[204:207]
  v_mfma_f32_32x32x16_bf16 v[48:63], v[108:111], v[96:99], v[48:63]
  ds_read_b64_tr_b16 v[136:137], v153 offset:64
  ds_read_b64_tr_b16 v[138:139], v153 offset:832
  v_add_f32_dpp v230, v230, v230 row_shr:2 row_mask:0xf bank_mask:0xf bound_ctrl:0
  v_add_f32_dpp v231, v231, v231 row_shr:2 row_mask:0xf bank_mask:0xf bound_ctrl:0
  s_waitcnt lgkmcnt(7)
  v_mfma_f32_32x32x16_bf16 v[64:79], v[112:115], v[96:99], v[64:79]
  ds_read_b64_tr_b16 v[140:141], v153 offset:128
  ds_read_b64_tr_b16 v[142:143], v153 offset:896
  buffer_load_dwordx4 v5, s[40:43], s98 offen offset:3072  lds
  v_add_f32_dpp v230, v230, v230 row_shr:4 row_mask:0xf bank_mask:0xf bound_ctrl:0
  v_add_f32_dpp v231, v231, v231 row_shr:4 row_mask:0xf bank_mask:0xf bound_ctrl:0
  v_mfma_f32_32x32x16_bf16 v[80:95], v[116:119], v[96:99], v[80:95]
  s_add_u32 m0, s83, 16384
  s_mov_b32 s99, 880640
  buffer_load_dwordx4 v6, s[44:47], s98 offen  lds
  v_add_f32_dpp v230, v230, v230 row_shr:8 row_mask:0xf bank_mask:0xf bound_ctrl:0
  v_add_f32_dpp v231, v231, v231 row_shr:8 row_mask:0xf bank_mask:0xf bound_ctrl:0
  s_waitcnt lgkmcnt(4)
  v_mfma_f32_32x32x16_bf16 v[16:31], v[120:123], v[124:127], v[16:31]
  ds_read_b128 v[96:99], v146 offset:0
  ds_read_b128 v[100:103], v150 offset:0
  ds_read_b128 v[104:107], v150 offset:4096
  v_add_f32_dpp v230, v230, v230 row_bcast:15 row_mask:0xa bank_mask:0xf
  v_mfma_f32_32x32x16_bf16 v[32:47], v[120:123], v[128:131], v[32:47]
  ds_read_b64_tr_b16 v[108:109], v154 offset:0
  ds_read_b64_tr_b16 v[110:111], v154 offset:768
  s_add_u32 m0, s83, 20480
  s_nop 0
  buffer_load_dwordx4 v6, s[48:51], s98 offen  lds
  v_add_f32_dpp v231, v231, v231 row_bcast:15 row_mask:0xa bank_mask:0xf
  v_mul_f32 v230, 0x3b000000, v230
  v_mfma_f32_32x32x16_bf16 v[48:63], v[132:135], v[120:123], v[48:63]
  ds_read_b64_tr_b16 v[112:113], v154 offset:64
  ds_read_b64_tr_b16 v[114:115], v154 offset:832
  v_mul_f32 v231, 0x3b000000, v231
  v_fma_f32 v231, -v230, v230, v231
  v_mfma_f32_16x16x32_bf16 v[208:211], v[156:159], v[132:135], v[208:211]
  s_waitcnt lgkmcnt(7)
  v_mfma_f32_32x32x16_bf16 v[64:79], v[136:139], v[120:123], v[64:79]
  ds_read_b64_tr_b16 v[116:117], v154 offset:128
  ds_read_b64_tr_b16 v[118:119], v154 offset:896
  s_add_u32 m0, s86, 24576
  s_nop 0
  buffer_load_dwordx4 v7, s[52:55], s99 offen offset:0  lds
  v_max_f32 v231, 0, v231
  v_cvt_pk_bf16_f32 v231, v231, v231
  v_mfma_f32_32x32x16_bf16 v[80:95], v[140:143], v[120:123], v[80:95]
  v_and_b32 v231, 0xffff0000, v231
  v_add_f32 v231, 0x3727c5ac, v231
  s_waitcnt lgkmcnt(4)
  v_mfma_f32_32x32x16_bf16 v[16:31], v[96:99], v[100:103], v[16:31]
  ds_read_b128 v[120:123], v147 offset:0
  ds_read_b128 v[124:127], v151 offset:0
  ds_read_b128 v[128:131], v151 offset:4096
  v_cvt_pk_bf16_f32 v231, v231, v231
  v_mfma_f32_32x32x16_bf16 v[32:47], v[96:99], v[104:107], v[32:47]
  ds_read_b64_tr_b16 v[132:133], v155 offset:0
  ds_read_b64_tr_b16 v[134:135], v155 offset:768
  buffer_load_dwordx4 v8, s[52:55], s99 offen offset:1024  lds
  v_and_b32 v231, 0xffff0000, v231
  v_sqrt_f32 v231, v231
  v_mfma_f32_32x32x16_bf16 v[48:63], v[108:111], v[96:99], v[48:63]
  ds_read_b64_tr_b16 v[136:137], v155 offset:64
  ds_read_b64_tr_b16 v[138:139], v155 offset:832
  v_mov_b32_e64 v242, s84
  v_cvt_pk_bf16_f32 v240, -v230, v231
  s_waitcnt lgkmcnt(7)
  v_mfma_f32_32x32x16_bf16 v[64:79], v[112:115], v[96:99], v[64:79]
  ds_read_b64_tr_b16 v[140:141], v155 offset:128
  ds_read_b64_tr_b16 v[142:143], v155 offset:896
  buffer_load_dwordx4 v9, s[52:55], s99 offen offset:2048  lds
  v_and_b32 v241, 0xffff0000, v240
  v_rcp_f32 v241, v241
  v_mfma_f32_16x16x32_bf16 v[212:215], v[156:159], v[112:115], v[212:215]
  v_mfma_f32_32x32x16_bf16 v[80:95], v[116:119], v[96:99], v[80:95]
  s_mov_b32 exec_lo, 0xffff
  s_cmp_eq_u32 s76, 2
  s_cselect_b32 exec_lo, 4194303, exec_lo
  s_cmp_eq_u32 s76, 3
  s_cselect_b32 exec_lo, 4290772992, exec_lo
  s_cselect_b32 exec_hi, 0x7ff, 0
  buffer_load_dword v253, v237, s[24:27], 0 offen
  s_mov_b64 exec, -1
  v_mov_b32 v243, s85
  s_mov_b32 exec_lo, 0x80000000
  s_mov_b32 exec_hi, 0x80000000
  buffer_store_dwordx4 v[240:243], v236, s[68:71], 0 offen sc1
  s_mov_b64 exec, -1
  s_waitcnt lgkmcnt(0)
  v_mfma_f32_32x32x16_bf16 v[16:31], v[120:123], v[124:127], v[16:31]
  s_waitcnt vmcnt(11)
  s_barrier
  ds_read_b128 v[96:99], v144 offset:4096
  ds_read_b128 v[100:103], v148 offset:8192
  ds_read_b128 v[104:107], v148 offset:12288
  v_mul_f32_e64 v168, v168, v226
  v_mfma_f32_32x32x16_bf16 v[32:47], v[120:123], v[128:131], v[32:47]
  ds_read_b64_tr_b16 v[108:109], v152 offset:12288
  ds_read_b64_tr_b16 v[110:111], v152 offset:13056
  s_add_u32 m0, s82, 0
  s_movk_i32 s98, 768
  buffer_load_dwordx4 v2, s[40:43], s98 offen offset:0  lds
  v_mul_f32_e64 v169, v169, v226
  v_mfma_f32_32x32x16_bf16 v[48:63], v[132:135], v[120:123], v[48:63]
  ds_read_b64_tr_b16 v[112:113], v152 offset:12352
  ds_read_b64_tr_b16 v[114:115], v152 offset:13120
  v_mfma_f32_32x32x16_bf16 v[64:79], v[136:139], v[120:123], v[64:79]
  ds_read_b64_tr_b16 v[116:117], v152 offset:12416
  ds_read_b64_tr_b16 v[118:119], v152 offset:13184
  buffer_load_dwordx4 v3, s[40:43], s98 offen offset:1024  lds
  v_mfma_f32_32x32x16_bf16 v[80:95], v[140:143], v[120:123], v[80:95]
  v_mfma_f32_16x16x32_bf16 v[216:219], v[156:159], v[140:143], v[216:219]
  s_waitcnt lgkmcnt(4)
  v_mfma_f32_32x32x16_bf16 v[16:31], v[96:99], v[100:103], v[16:31]
  ds_read_b128 v[120:123], v145 offset:4096
  ds_read_b128 v[124:127], v149 offset:8192
  ds_read_b128 v[128:131], v149 offset:12288
  v_mfma_f32_16x16x32_bf16 v[200:203], v[156:159], v[100:103], v[200:203]
  v_mfma_f32_32x32x16_bf16 v[32:47], v[96:99], v[104:107], v[32:47]
  ds_read_b64_tr_b16 v[132:133], v153 offset:12288
  ds_read_b64_tr_b16 v[134:135], v153 offset:13056
  buffer_load_dwordx4 v4, s[40:43], s98 offen offset:2048  lds
  v_mfma_f32_16x16x32_bf16 v[204:207], v[156:159], v[104:107], v[204:207]
  v_mfma_f32_32x32x16_bf16 v[48:63], v[108:111], v[96:99], v[48:63]
  ds_read_b64_tr_b16 v[136:137], v153 offset:12352
  ds_read_b64_tr_b16 v[138:139], v153 offset:13120
  s_waitcnt lgkmcnt(7)
  v_mfma_f32_32x32x16_bf16 v[64:79], v[112:115], v[96:99], v[64:79]
  ds_read_b64_tr_b16 v[140:141], v153 offset:12416
  ds_read_b64_tr_b16 v[142:143], v153 offset:13184
  buffer_load_dwordx4 v5, s[40:43], s98 offen offset:3072  lds
  v_mfma_f32_32x32x16_bf16 v[80:95], v[116:119], v[96:99], v[80:95]
  s_waitcnt lgkmcnt(4)
  v_mfma_f32_32x32x16_bf16 v[16:31], v[120:123], v[124:127], v[16:31]
  ds_read_b128 v[96:99], v146 offset:4096
  ds_read_b128 v[100:103], v150 offset:8192
  ds_read_b128 v[104:107], v150 offset:12288
  v_mfma_f32_32x32x16_bf16 v[32:47], v[120:123], v[128:131], v[32:47]
  ds_read_b64_tr_b16 v[108:109], v154 offset:12288
  ds_read_b64_tr_b16 v[110:111], v154 offset:13056
  s_add_u32 m0, s83, 0
  s_mov_b32 s99, 1056768
  buffer_load_dwordx4 v6, s[44:47], s98 offen  lds
  v_mfma_f32_32x32x16_bf16 v[48:63], v[132:135], v[120:123], v[48:63]
  ds_read_b64_tr_b16 v[112:113], v154 offset:12352
  ds_read_b64_tr_b16 v[114:115], v154 offset:13120
  v_mfma_f32_16x16x32_bf16 v[208:211], v[156:159], v[132:135], v[208:211]
  s_waitcnt lgkmcnt(7)
  v_mfma_f32_32x32x16_bf16 v[64:79], v[136:139], v[120:123], v[64:79]
  ds_read_b64_tr_b16 v[116:117], v154 offset:12416
  ds_read_b64_tr_b16 v[118:119], v154 offset:13184
  s_add_u32 m0, s83, 4096
  s_nop 0
  buffer_load_dwordx4 v6, s[48:51], s98 offen  lds
  v_mfma_f32_32x32x16_bf16 v[80:95], v[140:143], v[120:123], v[80:95]
  s_waitcnt lgkmcnt(4)
  v_mfma_f32_32x32x16_bf16 v[16:31], v[96:99], v[100:103], v[16:31]
  ds_read_b128 v[120:123], v147 offset:4096
  ds_read_b128 v[124:127], v151 offset:8192
  ds_read_b128 v[128:131], v151 offset:12288
  v_mfma_f32_32x32x16_bf16 v[32:47], v[96:99], v[104:107], v[32:47]
  ds_read_b64_tr_b16 v[132:133], v155 offset:12288
  ds_read_b64_tr_b16 v[134:135], v155 offset:13056
  s_add_u32 m0, s86, 0
  s_nop 0
  buffer_load_dwordx4 v7, s[52:55], s99 offen offset:0  lds
  v_mfma_f32_32x32x16_bf16 v[48:63], v[108:111], v[96:99], v[48:63]
  ds_read_b64_tr_b16 v[136:137], v155 offset:12352
  ds_read_b64_tr_b16 v[138:139], v155 offset:13120
  s_waitcnt lgkmcnt(7)
  v_mfma_f32_32x32x16_bf16 v[64:79], v[112:115], v[96:99], v[64:79]
  ds_read_b64_tr_b16 v[140:141], v155 offset:12416
  ds_read_b64_tr_b16 v[142:143], v155 offset:13184
  buffer_load_dwordx4 v8, s[52:55], s99 offen offset:1024  lds
  v_mfma_f32_16x16x32_bf16 v[212:215], v[156:159], v[112:115], v[212:215]
  v_mfma_f32_32x32x16_bf16 v[80:95], v[116:119], v[96:99], v[80:95]
  buffer_load_dwordx4 v9, s[52:55], s99 offen offset:2048  lds
  s_waitcnt lgkmcnt(0)
  v_mfma_f32_32x32x16_bf16 v[16:31], v[120:123], v[124:127], v[16:31]
  s_waitcnt vmcnt(11)
  s_barrier
  ds_read_b128 v[96:99], v144 offset:8192
  ds_read_b128 v[100:103], v148 offset:16384
  ds_read_b128 v[104:107], v148 offset:20480
  v_mfma_f32_32x32x16_bf16 v[32:47], v[120:123], v[128:131], v[32:47]
  ds_read_b64_tr_b16 v[108:109], v152 offset:24576
  ds_read_b64_tr_b16 v[110:111], v152 offset:25344
  s_add_u32 m0, s82, 4096
  s_movk_i32 s98, 896
  buffer_load_dwordx4 v2, s[40:43], s98 offen offset:0  lds
  v_mfma_f32_32x32x16_bf16 v[48:63], v[132:135], v[120:123], v[48:63]
  ds_read_b64_tr_b16 v[112:113], v152 offset:24640
  ds_read_b64_tr_b16 v[114:115], v152 offset:25408
  v_mfma_f32_32x32x16_bf16 v[64:79], v[136:139], v[120:123], v[64:79]
  ds_read_b64_tr_b16 v[116:117], v152 offset:24704
  ds_read_b64_tr_b16 v[118:119], v152 offset:25472
  buffer_load_dwordx4 v3, s[40:43], s98 offen offset:1024  lds
  v_mfma_f32_32x32x16_bf16 v[80:95], v[140:143], v[120:123], v[80:95]
  v_mfma_f32_16x16x32_bf16 v[216:219], v[156:159], v[140:143], v[216:219]
  s_waitcnt lgkmcnt(4)
  v_mfma_f32_32x32x16_bf16 v[16:31], v[96:99], v[100:103], v[16:31]
  ds_read_b128 v[120:123], v145 offset:8192
  ds_read_b128 v[124:127], v149 offset:16384
  ds_read_b128 v[128:131], v149 offset:20480
  v_mfma_f32_16x16x32_bf16 v[200:203], v[156:159], v[100:103], v[200:203]
  v_mfma_f32_32x32x16_bf16 v[32:47], v[96:99], v[104:107], v[32:47]
  ds_read_b64_tr_b16 v[132:133], v153 offset:24576
  ds_read_b64_tr_b16 v[134:135], v153 offset:25344
  buffer_load_dwordx4 v4, s[40:43], s98 offen offset:2048  lds
  v_mfma_f32_16x16x32_bf16 v[204:207], v[156:159], v[104:107], v[204:207]
  v_mfma_f32_32x32x16_bf16 v[48:63], v[108:111], v[96:99], v[48:63]
  ds_read_b64_tr_b16 v[136:137], v153 offset:24640
  ds_read_b64_tr_b16 v[138:139], v153 offset:25408
  s_waitcnt lgkmcnt(7)
  v_mfma_f32_32x32x16_bf16 v[64:79], v[112:115], v[96:99], v[64:79]
  ds_read_b64_tr_b16 v[140:141], v153 offset:24704
  ds_read_b64_tr_b16 v[142:143], v153 offset:25472
  buffer_load_dwordx4 v5, s[40:43], s98 offen offset:3072  lds
  v_mfma_f32_32x32x16_bf16 v[80:95], v[116:119], v[96:99], v[80:95]
  buffer_load_dwordx4 v[248:251], v14, s[68:71], 0 offen sc1
  s_waitcnt lgkmcnt(4)
  v_mfma_f32_32x32x16_bf16 v[16:31], v[120:123], v[124:127], v[16:31]
  ds_read_b128 v[96:99], v146 offset:8192
  ds_read_b128 v[100:103], v150 offset:16384
  ds_read_b128 v[104:107], v150 offset:20480
  v_mfma_f32_32x32x16_bf16 v[32:47], v[120:123], v[128:131], v[32:47]
  ds_read_b64_tr_b16 v[108:109], v154 offset:24576
  ds_read_b64_tr_b16 v[110:111], v154 offset:25344
  s_add_u32 m0, s83, 8192
  s_mov_b32 s99, 1232896
  buffer_load_dwordx4 v6, s[44:47], s98 offen  lds
  v_mfma_f32_32x32x16_bf16 v[48:63], v[132:135], v[120:123], v[48:63]
  ds_read_b64_tr_b16 v[112:113], v154 offset:24640
  ds_read_b64_tr_b16 v[114:115], v154 offset:25408
  v_mfma_f32_16x16x32_bf16 v[208:211], v[156:159], v[132:135], v[208:211]
  s_waitcnt lgkmcnt(7)
  v_mfma_f32_32x32x16_bf16 v[64:79], v[136:139], v[120:123], v[64:79]
  ds_read_b64_tr_b16 v[116:117], v154 offset:24704
  ds_read_b64_tr_b16 v[118:119], v154 offset:25472
  s_add_u32 m0, s83, 12288
  s_nop 0
  buffer_load_dwordx4 v6, s[48:51], s98 offen  lds
  v_mfma_f32_32x32x16_bf16 v[80:95], v[140:143], v[120:123], v[80:95]
  s_waitcnt lgkmcnt(4)
  v_mfma_f32_32x32x16_bf16 v[16:31], v[96:99], v[100:103], v[16:31]
  ds_read_b128 v[120:123], v147 offset:8192
  ds_read_b128 v[124:127], v151 offset:16384
  ds_read_b128 v[128:131], v151 offset:20480
  v_mfma_f32_32x32x16_bf16 v[32:47], v[96:99], v[104:107], v[32:47]
  ds_read_b64_tr_b16 v[132:133], v155 offset:24576
  ds_read_b64_tr_b16 v[134:135], v155 offset:25344
  s_add_u32 m0, s86, 12288
  s_nop 0
  buffer_load_dwordx4 v7, s[52:55], s99 offen offset:0  lds
  v_mfma_f32_32x32x16_bf16 v[48:63], v[108:111], v[96:99], v[48:63]
  ds_read_b64_tr_b16 v[136:137], v155 offset:24640
  ds_read_b64_tr_b16 v[138:139], v155 offset:25408
  s_waitcnt lgkmcnt(7)
  v_mfma_f32_32x32x16_bf16 v[64:79], v[112:115], v[96:99], v[64:79]
  ds_read_b64_tr_b16 v[140:141], v155 offset:24704
  ds_read_b64_tr_b16 v[142:143], v155 offset:25472
  buffer_load_dwordx4 v8, s[52:55], s99 offen offset:1024  lds
  v_mfma_f32_16x16x32_bf16 v[212:215], v[156:159], v[112:115], v[212:215]
  v_mfma_f32_32x32x16_bf16 v[80:95], v[116:119], v[96:99], v[80:95]
  buffer_load_dwordx4 v9, s[52:55], s99 offen offset:2048  lds
  s_waitcnt lgkmcnt(0)
  v_mfma_f32_32x32x16_bf16 v[16:31], v[120:123], v[124:127], v[16:31]
  s_waitcnt vmcnt(10)
  s_barrier
  ds_read_b128 v[96:99], v144 offset:0
  ds_read_b128 v[100:103], v148 offset:0
  ds_read_b128 v[104:107], v148 offset:4096
  v_mfma_f32_32x32x16_bf16 v[32:47], v[120:123], v[128:131], v[32:47]
  ds_read_b64_tr_b16 v[108:109], v152 offset:0
  ds_read_b64_tr_b16 v[110:111], v152 offset:768
  s_add_u32 m0, s82, 12288
  s_mov_b32 s98, 0
  buffer_load_dwordx4 v176, s[64:67], s98 offen offset:0 lds
  v_mfma_f32_32x32x16_bf16 v[48:63], v[132:135], v[120:123], v[48:63]
  ds_read_b64_tr_b16 v[112:113], v152 offset:64
  ds_read_b64_tr_b16 v[114:115], v152 offset:832
  v_mfma_f32_32x32x16_bf16 v[64:79], v[136:139], v[120:123], v[64:79]
  ds_read_b64_tr_b16 v[116:117], v152 offset:128
  ds_read_b64_tr_b16 v[118:119], v152 offset:896
  buffer_load_dwordx4 v177, s[64:67], s98 offen offset:1024 lds
  v_mfma_f32_32x32x16_bf16 v[80:95], v[140:143], v[120:123], v[80:95]
  buffer_load_dwordx4 v178, s[64:67], s98 offen offset:2048 lds
  v_mfma_f32_16x16x32_bf16 v[216:219], v[156:159], v[140:143], v[216:219]
  s_waitcnt lgkmcnt(4)
  v_mfma_f32_32x32x16_bf16 v[16:31], v[96:99], v[100:103], v[16:31]
  ds_read_b128 v[120:123], v145 offset:0
  ds_read_b128 v[124:127], v149 offset:0
  ds_read_b128 v[128:131], v149 offset:4096
  s_lshl_b32 s92, s80, 16
  v_mfma_f32_16x16x32_bf16 v[200:203], v[156:159], v[100:103], v[200:203]
  v_mfma_f32_32x32x16_bf16 v[32:47], v[96:99], v[104:107], v[32:47]
  ds_read_b64_tr_b16 v[132:133], v153 offset:0
  ds_read_b64_tr_b16 v[134:135], v153 offset:768
  buffer_load_dwordx4 v179, s[64:67], s98 offen offset:3072 lds
  s_lshl_b32 s93, s76, 8
  s_add_u32 s92, s92, s93
  v_mfma_f32_16x16x32_bf16 v[204:207], v[156:159], v[104:107], v[204:207]
  v_mfma_f32_32x32x16_bf16 v[48:63], v[108:111], v[96:99], v[48:63]
  ds_read_b64_tr_b16 v[136:137], v153 offset:64
  ds_read_b64_tr_b16 v[138:139], v153 offset:832
  s_mov_b32 s87, 0
  buffer_load_dwordx2 a[240:241], v224, s[40:43], s87 offen
  s_mov_b32 s87, 16384
  buffer_load_dwordx2 a[242:243], v224, s[40:43], s87 offen
  v_lshl_add_u32 v225, v232, 10, v233
  v_add_u32 v2, s92, v225
  v_xor_b32 v3, 64, v2
  s_waitcnt lgkmcnt(7)
  v_mfma_f32_32x32x16_bf16 v[64:79], v[112:115], v[96:99], v[64:79]
  ds_read_b64_tr_b16 v[140:141], v153 offset:128
  ds_read_b64_tr_b16 v[142:143], v153 offset:896
  s_mov_b32 s87, 32768
  buffer_load_dwordx2 a[244:245], v224, s[40:43], s87 offen
  s_mov_b32 s87, 49152
  buffer_load_dwordx2 a[246:247], v224, s[40:43], s87 offen
  v_add_u32 v4, 14336, v2
  v_add_u32 v5, 21504, v3
  v_mfma_f32_32x32x16_bf16 v[80:95], v[116:119], v[96:99], v[80:95]
  s_add_u32 m0, s82, 16384
  s_mov_b32 s98, 32768
  buffer_load_dwordx4 v176, s[64:67], s98 offen offset:0 lds
  v_add_u32 v3, 7168, v3
  s_sub_u32 s92, s36, s82
  v_add_u32_e64 v6, s92, v12
  s_waitcnt lgkmcnt(4)
  v_mfma_f32_32x32x16_bf16 v[16:31], v[120:123], v[124:127], v[16:31]
  ds_read_b128 v[96:99], v146 offset:0
  ds_read_b128 v[100:103], v150 offset:0
  ds_read_b128 v[104:107], v150 offset:4096
  v_add_u32_e64 v7, s92, v13
  v_mfma_f32_32x32x16_bf16 v[32:47], v[120:123], v[128:131], v[32:47]
  ds_read_b64_tr_b16 v[108:109], v154 offset:0
  ds_read_b64_tr_b16 v[110:111], v154 offset:768
  buffer_load_dwordx4 v177, s[64:67], s98 offen offset:1024 lds
  s_lshl_b32 s92, s76, 2
  s_add_u32 s92, s92, 147456
  v_mfma_f32_32x32x16_bf16 v[48:63], v[132:135], v[120:123], v[48:63]
  ds_read_b64_tr_b16 v[112:113], v154 offset:64
  ds_read_b64_tr_b16 v[114:115], v154 offset:832
  v_lshl_add_u32 v8, v10, 4, s92
  v_lshlrev_b32 v9, 4, v10
  v_add_u32 v9, 147456, v9
  v_mfma_f32_16x16x32_bf16 v[208:211], v[156:159], v[132:135], v[208:211]
  s_waitcnt lgkmcnt(7)
  v_mfma_f32_32x32x16_bf16 v[64:79], v[136:139], v[120:123], v[64:79]
  ds_read_b64_tr_b16 v[116:117], v154 offset:128
  ds_read_b64_tr_b16 v[118:119], v154 offset:896
  buffer_load_dwordx4 v178, s[64:67], s98 offen offset:2048 lds
  s_waitcnt vmcnt(16)
  v_cmp_eq_u32_e64 vcc, s84, v250
  v_cmp_eq_u32 s[22:23], s85, v251
  s_nop 0
  s_and_b64 vcc, vcc, s[22:23]
  s_cmp_eq_u64 vcc, -1
  s_cbranch_scc1 L_stat_ok
  s_mov_b32 s94, 0x40000
L_stat_spin:
  s_sleep 1
  buffer_load_dwordx4 v[248:251], v14, s[68:71], 0 offen sc1
  s_waitcnt vmcnt(0) lgkmcnt(0)
  v_cmp_eq_u32_e64 vcc, s84, v250
  v_cmp_eq_u32 s[22:23], s85, v251
  s_nop 0
  s_and_b64 vcc, vcc, s[22:23]
  s_cmp_eq_u64 vcc, -1
  s_cbranch_scc1 L_stat_ok
  s_sub_u32 s94, s94, 1
  s_cmp_lg_u32 s94, 0
  s_cbranch_scc1 L_stat_spin
L_stat_ok:
  v_mfma_f32_32x32x16_bf16 v[80:95], v[140:143], v[120:123], v[80:95]
  buffer_load_dwordx4 v179, s[64:67], s98 offen offset:3072 lds
  ds_write_b32 v15, v249
  v_cmp_gt_u32 vcc, 32, v0
  v_and_b32 v252, 0xffff, v248
  s_waitcnt lgkmcnt(5)
  v_mfma_f32_32x32x16_bf16 v[16:31], v[96:99], v[100:103], v[16:31]
  ds_read_b128 v[120:123], v147 offset:0
  ds_read_b128 v[124:127], v151 offset:0
  ds_read_b128 v[128:131], v151 offset:4096
  v_lshl_or_b32 v252, v252, 16, v252
  v_mfma_f32_32x32x16_bf16 v[32:47], v[96:99], v[104:107], v[32:47]
  ds_read_b64_tr_b16 v[132:133], v155 offset:0
  ds_read_b64_tr_b16 v[134:135], v155 offset:768
  s_add_u32 m0, s82, 20480
  s_mov_b32 s98, 65536
  buffer_load_dwordx4 v176, s[64:67], s98 offen offset:0 lds
  v_lshrrev_b32 v253, 16, v248
  v_cndmask_b32_e64 v252, 0, v252, vcc
  v_mfma_f32_32x32x16_bf16 v[48:63], v[108:111], v[96:99], v[48:63]
  ds_read_b64_tr_b16 v[136:137], v155 offset:64
  ds_read_b64_tr_b16 v[138:139], v155 offset:832
  buffer_load_dwordx4 v177, s[64:67], s98 offen offset:1024 lds
  v_cndmask_b32 v253, 0, v253, vcc
  v_mov_b32 v254, 0
  v_mov_b32 v255, 0
  s_waitcnt lgkmcnt(8)
  v_mfma_f32_32x32x16_bf16 v[64:79], v[112:115], v[96:99], v[64:79]
  ds_read_b64_tr_b16 v[140:141], v155 offset:128
  ds_read_b64_tr_b16 v[142:143], v155 offset:896
  buffer_load_dwordx4 v178, s[64:67], s98 offen offset:2048 lds
  s_waitcnt lgkmcnt(9)
  ds_read_b128 v[232:235], v229 offset:0
  v_mfma_f32_16x16x32_bf16 v[212:215], v[156:159], v[112:115], v[212:215]
  v_mfma_f32_32x32x16_bf16 v[80:95], v[116:119], v[96:99], v[80:95]
  buffer_load_dwordx4 v179, s[64:67], s98 offen offset:3072 lds
  ds_read_b128 v[236:239], v229 offset:16
  ds_read_b128 v[240:243], v229 offset:32
  ds_read_b128 v[244:247], v229 offset:48
  s_waitcnt lgkmcnt(0)
  v_mfma_f32_32x32x16_bf16 v[16:31], v[120:123], v[124:127], v[16:31]
  s_waitcnt vmcnt(16)
  s_barrier
  ds_read_b128 v[96:99], v144 offset:4096
  ds_read_b128 v[100:103], v148 offset:8192
  ds_read_b128 v[104:107], v148 offset:12288
  v_mul_f32_e64 v248, v249, v249
  v_mfma_f32_32x32x16_bf16 v[32:47], v[120:123], v[128:131], v[32:47]
  ds_read_b64_tr_b16 v[108:109], v152 offset:12288
  ds_read_b64_tr_b16 v[110:111], v152 offset:13056
  s_add_u32 m0, s82, 8192
  s_mov_b32 s98, 98304
  buffer_load_dwordx4 v176, s[64:67], s98 offen offset:0 lds
  s_waitcnt vmcnt(13)
  ds_read_b64_tr_b16 a[0:1], v12 offset:12288
  ds_read_b64_tr_b16 a[2:3], v12 offset:13312
  ds_read_b64_tr_b16 a[4:5], v13 offset:12288
  ds_read_b64_tr_b16 a[6:7], v13 offset:13312
  v_lshlrev_b32 v11, 4, v0
  v_mfma_f32_32x32x16_bf16 v[48:63], v[132:135], v[120:123], v[48:63]
  ds_read_b64_tr_b16 v[112:113], v152 offset:12352
  ds_read_b64_tr_b16 v[114:115], v152 offset:13120
  v_mfma_f32_32x32x16_bf16 v[64:79], v[136:139], v[120:123], v[64:79]
  ds_read_b64_tr_b16 v[116:117], v152 offset:12416
  ds_read_b64_tr_b16 v[118:119], v152 offset:13184
  buffer_load_dwordx4 v177, s[64:67], s98 offen offset:1024 lds
  ds_read_b64_tr_b16 a[8:9], v12 offset:14336
  ds_read_b64_tr_b16 a[10:11], v12 offset:15360
  ds_read_b64_tr_b16 a[12:13], v13 offset:14336
  ds_read_b64_tr_b16 a[14:15], v13 offset:15360
  v_mfma_f32_32x32x16_bf16 v[80:95], v[140:143], v[120:123], v[80:95]
  v_mfma_f32_16x16x32_bf16 v[216:219], v[156:159], v[140:143], v[216:219]
  s_waitcnt lgkmcnt(12)
  v_mfma_f32_32x32x16_bf16 v[16:31], v[96:99], v[100:103], v[16:31]
  ds_read_b128 v[120:123], v145 offset:4096
  ds_read_b128 v[124:127], v149 offset:8192
  ds_read_b128 v[128:131], v149 offset:12288
  v_mfma_f32_16x16x32_bf16 v[200:203], v[156:159], v[100:103], v[200:203]
  v_mfma_f32_32x32x16_bf16 v[32:47], v[96:99], v[104:107], v[32:47]
  ds_read_b64_tr_b16 v[132:133], v153 offset:12288
  ds_read_b64_tr_b16 v[134:135], v153 offset:13056
  buffer_load_dwordx4 v178, s[64:67], s98 offen offset:2048 lds
  v_mfma_f32_16x16x32_bf16 v[204:207], v[156:159], v[104:107], v[204:207]
  v_mfma_f32_32x32x16_bf16 v[48:63], v[108:111], v[96:99], v[48:63]
  ds_read_b64_tr_b16 v[136:137], v153 offset:12352
  ds_read_b64_tr_b16 v[138:139], v153 offset:13120
  v_mfma_f32_16x16x32_bf16 v[208:211], v[156:159], v[108:111], v[208:211]
  s_waitcnt lgkmcnt(11)
  v_mfma_f32_32x32x16_bf16 v[64:79], v[112:115], v[96:99], v[64:79]
  ds_read_b64_tr_b16 v[140:141], v153 offset:12416
  ds_read_b64_tr_b16 v[142:143], v153 offset:13184
  buffer_load_dwordx4 v179, s[64:67], s98 offen offset:3072 lds
  v_mfma_f32_16x16x32_bf16 v[212:215], v[156:159], v[112:115], v[212:215]
  v_mfma_f32_32x32x16_bf16 v[80:95], v[116:119], v[96:99], v[80:95]
  v_mfma_f32_16x16x32_bf16 v[216:219], v[156:159], v[116:119], v[216:219]
  s_waitcnt lgkmcnt(4)
  v_mfma_f32_32x32x16_bf16 v[16:31], v[120:123], v[124:127], v[16:31]
  ds_write_b32 v8, v200 offset:0
  ds_write_b32 v8, v204 offset:512
  ds_write_b32 v8, v208 offset:1024
  ds_read_b128 v[96:99], v146 offset:4096
  v_mfma_f32_32x32x16_bf16 v[32:47], v[120:123], v[128:131], v[32:47]
  ds_read_b128 v[100:103], v150 offset:8192
  ds_read_b128 v[104:107], v150 offset:12288
  ds_write_b32 v8, v212 offset:1536
  ds_write_b32 v8, v216 offset:2048
  s_add_u32 m0, s82, 12288
  s_mov_b32 s98, 131072
  buffer_load_dwordx4 v176, s[64:67], s98 offen offset:0 lds
  v_mfma_f32_32x32x16_bf16 v[48:63], v[132:135], v[120:123], v[48:63]
  ds_read_b64_tr_b16 v[108:109], v154 offset:12288
  ds_read_b64_tr_b16 v[110:111], v154 offset:13056
  ds_read_b64_tr_b16 v[112:113], v154 offset:12352
  s_waitcnt lgkmcnt(11)
  v_mfma_f32_32x32x16_bf16 v[64:79], v[136:139], v[120:123], v[64:79]
  ds_read_b64_tr_b16 v[114:115], v154 offset:13120
  ds_read_b64_tr_b16 v[116:117], v154 offset:12416
  ds_read_b64_tr_b16 v[118:119], v154 offset:13184
  buffer_load_dwordx4 v177, s[64:67], s98 offen offset:1024 lds
  v_mfma_f32_32x32x16_bf16 v[80:95], v[140:143], v[120:123], v[80:95]
  s_waitcnt lgkmcnt(6)
  s_barrier
  s_waitcnt lgkmcnt(4)
  v_mfma_f32_32x32x16_bf16 v[16:31], v[96:99], v[100:103], v[16:31]
  ds_read_b128 v[200:203], v9 offset:0
  ds_read_b128 v[204:207], v9 offset:512
  ds_read_b128 v[208:211], v9 offset:1024
  ds_read_b128 v[212:215], v9 offset:1536
  v_mfma_f32_32x32x16_bf16 v[32:47], v[96:99], v[104:107], v[32:47]
  ds_read_b128 v[216:219], v9 offset:2048
  ds_read_b128 v[120:123], v147 offset:4096
  ds_read_b128 v[124:127], v151 offset:8192
  ds_read_b128 v[128:131], v151 offset:12288
  buffer_load_dwordx4 v178, s[64:67], s98 offen offset:2048 lds
  v_mfma_f32_32x32x16_bf16 v[48:63], v[108:111], v[96:99], v[48:63]
  ds_read_b64_tr_b16 v[132:133], v155 offset:12288
  ds_read_b64_tr_b16 v[134:135], v155 offset:13056
  ds_read_b64_tr_b16 v[136:137], v155 offset:12352
  s_waitcnt lgkmcnt(9)
  v_add_f32 v200, v200, v201
  v_add_f32 v202, v202, v203
  v_mfma_f32_32x32x16_bf16 v[64:79], v[112:115], v[96:99], v[64:79]
  ds_read_b64_tr_b16 v[138:139], v155 offset:13120
  ds_read_b64_tr_b16 v[140:141], v155 offset:12416
  ds_read_b64_tr_b16 v[142:143], v155 offset:13184
  buffer_load_dwordx4 v179, s[64:67], s98 offen offset:3072 lds
  v_add_f32_e64 v200, v200, v202
  v_cvt_pk_bf16_f32 v201, v200, v200
  v_and_b32 v201, 0xffff0000, v201
  v_sub_f32_e64 v201, v200, v201
  v_mfma_f32_32x32x16_bf16 v[80:95], v[116:119], v[96:99], v[80:95]
  v_cvt_pk_bf16_f32 v180, v200, v201
  v_add_f32 v204, v204, v205
  v_add_f32 v206, v206, v207
  v_add_f32_e64 v204, v204, v206
  v_cvt_pk_bf16_f32 v205, v204, v204
  v_and_b32 v205, 0xffff0000, v205
  s_waitcnt lgkmcnt(6)
  v_mfma_f32_32x32x16_bf16 v[16:31], v[120:123], v[124:127], v[16:31]
  v_sub_f32 v205, v204, v205
  v_cvt_pk_bf16_f32 v184, v204, v205
  v_add_f32 v208, v208, v209
  v_add_f32 v210, v210, v211
  v_mfma_f32_32x32x16_bf16 v[32:47], v[120:123], v[128:131], v[32:47]
  v_add_f32_e64 v208, v208, v210
  v_cvt_pk_bf16_f32 v209, v208, v208
  v_and_b32 v209, 0xffff0000, v209
  v_sub_f32_e64 v209, v208, v209
  v_cvt_pk_bf16_f32 v188, v208, v209
  v_mfma_f32_32x32x16_bf16 v[16:31], v[252:255], v[180:183], v[16:31]
  v_add_f32 v212, v212, v213
  v_add_f32 v214, v214, v215
  v_add_f32_e64 v212, v212, v214
  v_cvt_pk_bf16_f32 v213, v212, v212
  v_and_b32 v213, 0xffff0000, v213
  v_mfma_f32_32x32x16_bf16 v[32:47], v[252:255], v[184:187], v[32:47]
  v_sub_f32_e64 v213, v212, v213
  v_cvt_pk_bf16_f32 v192, v212, v213
  v_add_f32 v216, v216, v217
  v_add_f32 v218, v218, v219
  v_add_f32 v216, v216, v218
  s_waitcnt lgkmcnt(0)
  v_mfma_f32_32x32x16_bf16 v[48:63], v[132:135], v[120:123], v[48:63]
  v_cvt_pk_bf16_f32 v217, v216, v216
  v_and_b32 v217, 0xffff0000, v217
  v_sub_f32_e64 v217, v216, v217
  v_cvt_pk_bf16_f32 v196, v216, v217
  s_add_u32 m0, s82, 0
  s_mov_b32 s98, 163840
  buffer_load_dwordx4 v176, s[64:67], s98 offen offset:0 lds
  v_mfma_f32_32x32x16_bf16 v[48:63], v[188:191], v[252:255], v[48:63]
  v_mul_f32 v16, v16, v232
  v_mul_f32 v17, v17, v233
  v_mul_f32 v18, v18, v234
  v_mul_f32_e64 v19, v19, v235
  buffer_load_dwordx4 v177, s[64:67], s98 offen offset:1024 lds
  v_mfma_f32_32x32x16_bf16 v[64:79], v[136:139], v[120:123], v[64:79]
  v_mul_f32 v20, v20, v236
  v_mul_f32 v21, v21, v237
  v_mul_f32 v22, v22, v238
  v_mul_f32 v23, v23, v239
  v_mul_f32_e64 v24, v24, v240
  v_mfma_f32_32x32x16_bf16 v[64:79], v[192:195], v[252:255], v[64:79]
  v_mul_f32 v25, v25, v241
  v_mul_f32 v26, v26, v242
  v_mul_f32 v27, v27, v243
  v_mul_f32 v28, v28, v244
  buffer_load_dwordx4 v178, s[64:67], s98 offen offset:2048 lds
  v_mfma_f32_32x32x16_bf16 v[80:95], v[140:143], v[120:123], v[80:95]
  v_mul_f32 v29, v29, v245
  v_mul_f32 v30, v30, v246
  v_mul_f32 v31, v31, v247
  v_mul_f32 v32, v32, v232
  v_mul_f32_e64 v33, v33, v233
  v_mfma_f32_32x32x16_bf16 v[80:95], v[196:199], v[252:255], v[80:95]
  v_mul_f32 v34, v34, v234
  v_mul_f32 v35, v35, v235
  v_mul_f32 v36, v36, v236
  v_mul_f32 v37, v37, v237
  buffer_load_dwordx4 v179, s[64:67], s98 offen offset:3072 lds
  v_pk_mul_f32 v[38:39], v[38:39], v[238:239]
  v_pk_mul_f32 v[40:41], v[40:41], v[240:241]
  v_pk_mul_f32 v[42:43], v[42:43], v[242:243]
  v_pk_mul_f32 v[44:45], v[44:45], v[244:245]
  v_pk_mul_f32 v[46:47], v[46:47], v[246:247]
  v_pk_mul_f32 v[200:201], v[16:17], v[168:169] op_sel:[0,0] op_sel_hi:[0,1]
  v_pk_fma_f32 v[200:201], v[32:33], v[168:169], v[200:201] op_sel:[0,1,0] op_sel_hi:[0,0,1] neg_lo:[0,1,0]
  v_pk_mul_f32 v[202:203], v[16:17], v[168:169] op_sel:[1,0] op_sel_hi:[1,1]
  v_pk_fma_f32 v[202:203], v[32:33], v[168:169], v[202:203] op_sel:[1,1,0] op_sel_hi:[1,0,1] neg_lo:[0,1,0]
  s_add_u32 m0, s82, 4096
  s_mov_b32 s98, 196608
  buffer_load_dwordx4 v176, s[64:67], s98 offen offset:0 lds
  v_pk_fma_f32 v[98:99], v[200:201], v[162:163], v[202:203] op_sel:[1,1,0] op_sel_hi:[0,1,1] neg_lo:[0,1,0]
  v_pk_fma_f32 v[96:97], v[200:201], v[162:163], v[98:99] op_sel_hi:[1,0,1]
  v_pk_mul_f32 v[204:205], v[18:19], v[168:169] op_sel:[0,0] op_sel_hi:[0,1]
  v_pk_fma_f32 v[204:205], v[34:35], v[168:169], v[204:205] op_sel:[0,1,0] op_sel_hi:[0,0,1] neg_lo:[0,1,0]
  v_pk_fma_f32 v[98:99], v[96:97], v[162:163], v[204:205] op_sel:[1,1,0] op_sel_hi:[0,1,1] neg_lo:[0,1,0]
  v_pk_fma_f32 v[96:97], v[96:97], v[162:163], v[98:99] op_sel_hi:[1,0,1]
  v_pk_mul_f32 v[206:207], v[18:19], v[168:169] op_sel:[1,0] op_sel_hi:[1,1]
  v_pk_fma_f32 v[206:207], v[34:35], v[168:169], v[206:207] op_sel:[1,1,0] op_sel_hi:[1,0,1] neg_lo:[0,1,0]
  v_pk_fma_f32 v[98:99], v[96:97], v[162:163], v[206:207] op_sel:[1,1,0] op_sel_hi:[0,1,1] neg_lo:[0,1,0]
  buffer_load_dwordx4 v177, s[64:67], s98 offen offset:1024 lds
  v_pk_fma_f32 v[96:97], v[96:97], v[162:163], v[98:99] op_sel_hi:[1,0,1]
  v_pk_mul_f32 v[208:209], v[20:21], v[168:169] op_sel:[0,0] op_sel_hi:[0,1]
  v_pk_fma_f32 v[208:209], v[36:37], v[168:169], v[208:209] op_sel:[0,1,0] op_sel_hi:[0,0,1] neg_lo:[0,1,0]
  v_pk_fma_f32 v[98:99], v[96:97], v[162:163], v[208:209] op_sel:[1,1,0] op_sel_hi:[0,1,1] neg_lo:[0,1,0]
  v_pk_fma_f32 v[96:97], v[96:97], v[162:163], v[98:99] op_sel_hi:[1,0,1]
  v_pk_mul_f32 v[210:211], v[20:21], v[168:169] op_sel:[1,0] op_sel_hi:[1,1]
  v_pk_fma_f32 v[210:211], v[36:37], v[168:169], v[210:211] op_sel:[1,1,0] op_sel_hi:[1,0,1] neg_lo:[0,1,0]
  v_pk_fma_f32 v[98:99], v[96:97], v[162:163], v[210:211] op_sel:[1,1,0] op_sel_hi:[0,1,1] neg_lo:[0,1,0]
  v_pk_fma_f32 v[96:97], v[96:97], v[162:163], v[98:99] op_sel_hi:[1,0,1]
  buffer_load_dwordx4 v178, s[64:67], s98 offen offset:2048 lds
  v_pk_mul_f32 v[212:213], v[22:23], v[168:169] op_sel:[0,0] op_sel_hi:[0,1]
  v_pk_fma_f32 v[212:213], v[38:39], v[168:169], v[212:213] op_sel:[0,1,0] op_sel_hi:[0,0,1] neg_lo:[0,1,0]
  v_pk_fma_f32 v[98:99], v[96:97], v[162:163], v[212:213] op_sel:[1,1,0] op_sel_hi:[0,1,1] neg_lo:[0,1,0]
  v_pk_fma_f32 v[96:97], v[96:97], v[162:163], v[98:99] op_sel_hi:[1,0,1]
  v_pk_mul_f32 v[214:215], v[22:23], v[168:169] op_sel:[1,0] op_sel_hi:[1,1]
  v_pk_fma_f32 v[214:215], v[38:39], v[168:169], v[214:215] op_sel:[1,1,0] op_sel_hi:[1,0,1] neg_lo:[0,1,0]
  v_pk_fma_f32 v[98:99], v[96:97], v[162:163], v[214:215] op_sel:[1,1,0] op_sel_hi:[0,1,1] neg_lo:[0,1,0]
  v_pk_fma_f32 v[96:97], v[96:97], v[162:163], v[98:99] op_sel_hi:[1,0,1]
  v_pk_mul_f32 v[216:217], v[24:25], v[168:169] op_sel:[0,0] op_sel_hi:[0,1]
  buffer_load_dwordx4 v179, s[64:67], s98 offen offset:3072 lds
  v_pk_fma_f32 v[216:217], v[40:41], v[168:169], v[216:217] op_sel:[0,1,0] op_sel_hi:[0,0,1] neg_lo:[0,1,0]
  v_pk_fma_f32 v[98:99], v[96:97], v[162:163], v[216:217] op_sel:[1,1,0] op_sel_hi:[0,1,1] neg_lo:[0,1,0]
  v_pk_fma_f32 v[96:97], v[96:97], v[162:163], v[98:99] op_sel_hi:[1,0,1]
  v_pk_mul_f32 v[218:219], v[24:25], v[168:169] op_sel:[1,0] op_sel_hi:[1,1]
  v_pk_fma_f32 v[218:219], v[40:41], v[168:169], v[218:219] op_sel:[1,1,0] op_sel_hi:[1,0,1] neg_lo:[0,1,0]
  v_pk_fma_f32 v[98:99], v[96:97], v[162:163], v[218:219] op_sel:[1,1,0] op_sel_hi:[0,1,1] neg_lo:[0,1,0]
  v_pk_fma_f32 v[96:97], v[96:97], v[162:163], v[98:99] op_sel_hi:[1,0,1]
  v_pk_mul_f32 v[220:221], v[26:27], v[168:169] op_sel:[0,0] op_sel_hi:[0,1]
  v_pk_fma_f32 v[220:221], v[42:43], v[168:169], v[220:221] op_sel:[0,1,0] op_sel_hi:[0,0,1] neg_lo:[0,1,0]
  s_waitcnt vmcnt(20)
  ds_read_b64_tr_b16 a[16:17], v12 offset:16384
  ds_read_b64_tr_b16 a[18:19], v12 offset:17408
  ds_read_b64_tr_b16 a[20:21], v13 offset:16384
  ds_read_b64_tr_b16 a[22:23], v13 offset:17408
  v_pk_fma_f32 v[98:99], v[96:97], v[162:163], v[220:221] op_sel:[1,1,0] op_sel_hi:[0,1,1] neg_lo:[0,1,0]
  v_pk_fma_f32 v[96:97], v[96:97], v[162:163], v[98:99] op_sel_hi:[1,0,1]
  v_pk_mul_f32 v[222:223], v[26:27], v[168:169] op_sel:[1,0] op_sel_hi:[1,1]
  v_pk_fma_f32 v[222:223], v[42:43], v[168:169], v[222:223] op_sel:[1,1,0] op_sel_hi:[1,0,1] neg_lo:[0,1,0]
  v_pk_fma_f32 v[98:99], v[96:97], v[162:163], v[222:223] op_sel:[1,1,0] op_sel_hi:[0,1,1] neg_lo:[0,1,0]
  v_pk_fma_f32 v[96:97], v[96:97], v[162:163], v[98:99] op_sel_hi:[1,0,1]
  v_pk_mul_f32 v[224:225], v[28:29], v[168:169] op_sel:[0,0] op_sel_hi:[0,1]
  v_pk_fma_f32 v[224:225], v[44:45], v[168:169], v[224:225] op_sel:[0,1,0] op_sel_hi:[0,0,1] neg_lo:[0,1,0]
  v_pk_fma_f32 v[98:99], v[96:97], v[162:163], v[224:225] op_sel:[1,1,0] op_sel_hi:[0,1,1] neg_lo:[0,1,0]
  ds_read_b64_tr_b16 a[24:25], v12 offset:18432
  ds_read_b64_tr_b16 a[26:27], v12 offset:19456
  ds_read_b64_tr_b16 a[28:29], v13 offset:18432
  ds_read_b64_tr_b16 a[30:31], v13 offset:19456
  v_pk_fma_f32 v[96:97], v[96:97], v[162:163], v[98:99] op_sel_hi:[1,0,1]
  v_pk_mul_f32 v[226:227], v[28:29], v[168:169] op_sel:[1,0] op_sel_hi:[1,1]
  v_pk_fma_f32 v[226:227], v[44:45], v[168:169], v[226:227] op_sel:[1,1,0] op_sel_hi:[1,0,1] neg_lo:[0,1,0]
  v_pk_fma_f32 v[98:99], v[96:97], v[162:163], v[226:227] op_sel:[1,1,0] op_sel_hi:[0,1,1] neg_lo:[0,1,0]
  v_pk_fma_f32 v[96:97], v[96:97], v[162:163], v[98:99] op_sel_hi:[1,0,1]
  v_pk_mul_f32 v[228:229], v[30:31], v[168:169] op_sel:[0,0] op_sel_hi:[0,1]
  v_pk_fma_f32 v[228:229], v[46:47], v[168:169], v[228:229] op_sel:[0,1,0] op_sel_hi:[0,0,1] neg_lo:[0,1,0]
  v_pk_fma_f32 v[98:99], v[96:97], v[162:163], v[228:229] op_sel:[1,1,0] op_sel_hi:[0,1,1] neg_lo:[0,1,0]
  v_pk_fma_f32 v[96:97], v[96:97], v[162:163], v[98:99] op_sel_hi:[1,0,1]
  s_waitcnt vmcnt(16)
  ds_read_b64_tr_b16 a[32:33], v12 offset:20480
  ds_read_b64_tr_b16 a[34:35], v12 offset:21504
  ds_read_b64_tr_b16 a[36:37], v13 offset:20480
  ds_read_b64_tr_b16 a[38:39], v13 offset:21504
  v_pk_mul_f32 v[230:231], v[30:31], v[168:169] op_sel:[1,0] op_sel_hi:[1,1]
  v_pk_fma_f32 v[230:231], v[46:47], v[168:169], v[230:231] op_sel:[1,1,0] op_sel_hi:[1,0,1] neg_lo:[0,1,0]
  v_pk_fma_f32 v[98:99], v[96:97], v[162:163], v[230:231] op_sel:[1,1,0] op_sel_hi:[0,1,1] neg_lo:[0,1,0]
  v_pk_fma_f32 v[96:97], v[96:97], v[162:163], v[98:99] op_sel_hi:[1,0,1]
  s_lshl_b32 s92, s76, 9
  s_add_u32 s92, s92, 150528
  v_lshl_add_u32 v8, v0, 3, s92
  ds_write_b64 v8, v[96:97]
  v_lshlrev_b32 v15, 3, v10
  ds_read_b64_tr_b16 a[40:41], v12 offset:22528
  ds_read_b64_tr_b16 a[42:43], v12 offset:23552
  ds_read_b64_tr_b16 a[44:45], v13 offset:22528
  ds_read_b64_tr_b16 a[46:47], v13 offset:23552
  v_add_u32 v15, 150528, v15
  v_mov_b32 v100, 0
  v_mov_b32_e64 v101, 0
  s_lshl_b32 s93, s78, 9
  s_add_u32 s93, s93, 4096
  v_lshl_add_u32 v14, v10, 4, s93
  v_mov_b32 v106, s84
  v_mov_b32_e64 v107, s85
  s_lshl_b32 s93, s77, 13
  s_waitcnt lgkmcnt(4)
  s_barrier
  ds_read_b64 v[184:185], v15 offset:0
  ds_read_b64 v[186:187], v15 offset:256
  ds_read_b64 v[188:189], v15 offset:512
  ds_read_b64 v[190:191], v15 offset:768
  ds_read_b64 v[192:193], v15 offset:1024
  ds_read_b64 v[194:195], v15 offset:1280
  ds_read_b64 v[196:197], v15 offset:1536
  s_add_u32 m0, s36, 0
  s_mov_b32 s98, 229376
  buffer_load_dwordx4 v176, s[64:67], s98 offen offset:0 lds
  buffer_load_dwordx4 v177, s[64:67], s98 offen offset:1024 lds
  s_waitcnt lgkmcnt(0)
  s_mov_b64 exec, s[4:5]
  v_pk_fma_f32 v[98:99], v[100:101], v[164:165], v[184:185] op_sel:[1,1,0] op_sel_hi:[0,1,1] neg_lo:[0,1,0]
  v_pk_fma_f32 v[100:101], v[100:101], v[164:165], v[98:99] op_sel_hi:[1,0,1]
  s_mov_b64 exec, s[6:7]
  v_pk_fma_f32 v[98:99], v[100:101], v[164:165], v[186:187] op_sel:[1,1,0] op_sel_hi:[0,1,1] neg_lo:[0,1,0]
  v_pk_fma_f32 v[100:101], v[100:101], v[164:165], v[98:99] op_sel_hi:[1,0,1]
  s_mov_b64 exec, s[8:9]
  v_pk_fma_f32 v[98:99], v[100:101], v[164:165], v[188:189] op_sel:[1,1,0] op_sel_hi:[0,1,1] neg_lo:[0,1,0]
  v_pk_fma_f32 v[100:101], v[100:101], v[164:165], v[98:99] op_sel_hi:[1,0,1]
  s_mov_b64 exec, s[12:13]
  v_pk_fma_f32 v[98:99], v[100:101], v[164:165], v[190:191] op_sel:[1,1,0] op_sel_hi:[0,1,1] neg_lo:[0,1,0]
  v_pk_fma_f32 v[100:101], v[100:101], v[164:165], v[98:99] op_sel_hi:[1,0,1]
  s_mov_b64 exec, s[16:17]
  v_pk_fma_f32 v[98:99], v[100:101], v[164:165], v[192:193] op_sel:[1,1,0] op_sel_hi:[0,1,1] neg_lo:[0,1,0]
  v_pk_fma_f32 v[100:101], v[100:101], v[164:165], v[98:99] op_sel_hi:[1,0,1]
  s_mov_b64 exec, s[28:29]
  v_pk_fma_f32 v[98:99], v[100:101], v[164:165], v[194:195] op_sel:[1,1,0] op_sel_hi:[0,1,1] neg_lo:[0,1,0]
  v_pk_fma_f32 v[100:101], v[100:101], v[164:165], v[98:99] op_sel_hi:[1,0,1]
  s_mov_b64 exec, s[30:31]
  v_pk_fma_f32 v[98:99], v[100:101], v[164:165], v[196:197] op_sel:[1,1,0] op_sel_hi:[0,1,1] neg_lo:[0,1,0]
  v_pk_fma_f32 v[100:101], v[100:101], v[164:165], v[98:99] op_sel_hi:[1,0,1]
  s_mov_b64 exec, -1
  s_cmp_lg_u32 s76, 3
  s_cbranch_scc1 L_nopub
  v_pk_fma_f32 v[98:99], v[100:101], v[164:165], v[96:97] op_sel:[1,1,0] op_sel_hi:[0,1,1] neg_lo:[0,1,0]
  v_pk_fma_f32 v[104:105], v[100:101], v[164:165], v[98:99] op_sel_hi:[1,0,1]
  s_mov_b32 exec_lo, 0
  buffer_store_dwordx4 v[104:107], v14, s[68:71], s93 offen sc1
  s_mov_b64 exec, -1
L_nopub:
  buffer_load_dwordx4 v178, s[64:67], s98 offen offset:2048 lds
  buffer_load_dwordx4 v179, s[64:67], s98 offen offset:3072 lds
  v_pk_mul_f32 v[180:181], v[48:49], v[248:249] op_sel_hi:[1,0]
  v_mul_f32 v180, v180, |v48|
  v_mul_f32 v181, v181, |v49|
  v_cvt_pk_bf16_f32 v120, v180, v181
  v_pk_max_i16 v120, v120, 0
  v_pk_mul_f32 v[182:183], v[50:51], v[248:249] op_sel_hi:[1,0]
  v_mul_f32 v182, v182, |v50|
  v_mul_f32 v183, v183, |v51|
  v_cvt_pk_bf16_f32 v121, v182, v183
  v_pk_max_i16 v121, v121, 0
  v_pk_mul_f32 v[180:181], v[52:53], v[248:249] op_sel_hi:[1,0]
  v_mul_f32 v180, v180, |v52|
  v_mul_f32 v181, v181, |v53|
  v_cvt_pk_bf16_f32 v122, v180, v181
  v_pk_max_i16 v122, v122, 0
  v_pk_mul_f32 v[182:183], v[54:55], v[248:249] op_sel_hi:[1,0]
  v_mul_f32 v182, v182, |v54|
  v_mul_f32 v183, v183, |v55|
  v_cvt_pk_bf16_f32 v123, v182, v183
  v_pk_max_i16 v123, v123, 0
  s_waitcnt vmcnt(16)
  ds_read_b64_tr_b16 a[48:49], v12 offset:8192
  ds_read_b64_tr_b16 a[50:51], v12 offset:9216
  ds_read_b64_tr_b16 a[52:53], v13 offset:8192
  ds_read_b64_tr_b16 a[54:55], v13 offset:9216
  buffer_store_dwordx4 v[120:123], v11, s[68:71], s32 offen offset:0 sc1
  v_pk_mul_f32 v[180:181], v[56:57], v[248:249] op_sel_hi:[1,0]
  v_mul_f32 v180, v180, |v56|
  v_mul_f32 v181, v181, |v57|
  v_cvt_pk_bf16_f32 v124, v180, v181
  v_pk_max_i16 v124, v124, 0
  v_pk_mul_f32 v[182:183], v[58:59], v[248:249] op_sel_hi:[1,0]
  v_mul_f32 v182, v182, |v58|
  v_mul_f32 v183, v183, |v59|
  v_cvt_pk_bf16_f32 v125, v182, v183
  v_pk_max_i16 v125, v125, 0
  v_pk_mul_f32 v[180:181], v[60:61], v[248:249] op_sel_hi:[1,0]
  v_mul_f32 v180, v180, |v60|
  v_mul_f32 v181, v181, |v61|
  v_cvt_pk_bf16_f32 v126, v180, v181
  v_pk_max_i16 v126, v126, 0
  v_pk_mul_f32 v[182:183], v[62:63], v[248:249] op_sel_hi:[1,0]
  v_mul_f32 v182, v182, |v62|
  v_mul_f32 v183, v183, |v63|
  v_cvt_pk_bf16_f32 v127, v182, v183
  ds_read_b64_tr_b16 a[56:57], v12 offset:10240
  ds_read_b64_tr_b16 a[58:59], v12 offset:11264
  ds_read_b64_tr_b16 a[60:61], v13 offset:10240
  ds_read_b64_tr_b16 a[62:63], v13 offset:11264
  v_pk_max_i16 v127, v127, 0
  buffer_store_dwordx4 v[124:127], v11, s[68:71], s32 offen offset:1024 sc1
  v_pk_mul_f32 v[180:181], v[64:65], v[248:249] op_sel_hi:[1,0]
  v_mul_f32 v180, v180, |v64|
  v_mul_f32 v181, v181, |v65|
  v_cvt_pk_bf16_f32 v128, v180, v181
  v_pk_max_i16 v128, v128, 0
  v_pk_mul_f32 v[182:183], v[66:67], v[248:249] op_sel_hi:[1,0]
  v_mul_f32 v182, v182, |v66|
  v_mul_f32 v183, v183, |v67|
  v_cvt_pk_bf16_f32 v129, v182, v183
  v_pk_max_i16 v129, v129, 0
  v_pk_mul_f32 v[180:181], v[68:69], v[248:249] op_sel_hi:[1,0]
  v_mul_f32 v180, v180, |v68|
  v_mul_f32 v181, v181, |v69|
  v_cvt_pk_bf16_f32 v130, v180, v181
  v_pk_max_i16 v130, v130, 0
  v_pk_mul_f32 v[182:183], v[70:71], v[248:249] op_sel_hi:[1,0]
  v_mul_f32 v182, v182, |v70|
  v_mul_f32 v183, v183, |v71|
  v_cvt_pk_bf16_f32 v131, v182, v183
  v_pk_max_i16 v131, v131, 0
  s_waitcnt vmcnt(14)
  ds_read_b64_tr_b16 a[64:65], v12 offset:12288
  ds_read_b64_tr_b16 a[66:67], v12 offset:13312
  ds_read_b64_tr_b16 a[68:69], v13 offset:12288
  ds_read_b64_tr_b16 a[70:71], v13 offset:13312
  buffer_store_dwordx4 v[128:131], v11, s[68:71], s33 offen offset:0 sc1
  v_pk_mul_f32 v[180:181], v[72:73], v[248:249] op_sel_hi:[1,0]
  v_mul_f32 v180, v180, |v72|
  v_mul_f32 v181, v181, |v73|
  v_cvt_pk_bf16_f32 v132, v180, v181
  v_pk_max_i16 v132, v132, 0
  v_pk_mul_f32 v[182:183], v[74:75], v[248:249] op_sel_hi:[1,0]
  v_mul_f32 v182, v182, |v74|
  v_mul_f32 v183, v183, |v75|
  v_cvt_pk_bf16_f32 v133, v182, v183
  v_pk_max_i16 v133, v133, 0
  v_pk_mul_f32 v[180:181], v[76:77], v[248:249] op_sel_hi:[1,0]
  v_mul_f32 v180, v180, |v76|
  v_mul_f32 v181, v181, |v77|
  v_cvt_pk_bf16_f32 v134, v180, v181
  v_pk_max_i16 v134, v134, 0
  v_pk_mul_f32 v[182:183], v[78:79], v[248:249] op_sel_hi:[1,0]
  v_mul_f32 v182, v182, |v78|
  v_mul_f32 v183, v183, |v79|
  v_cvt_pk_bf16_f32 v135, v182, v183
  ds_read_b64_tr_b16 a[72:73], v12 offset:14336
  ds_read_b64_tr_b16 a[74:75], v12 offset:15360
  ds_read_b64_tr_b16 a[76:77], v13 offset:14336
  ds_read_b64_tr_b16 a[78:79], v13 offset:15360
  v_pk_max_i16 v135, v135, 0
  buffer_store_dwordx4 v[132:135], v11, s[68:71], s33 offen offset:1024 sc1
  v_pk_mul_f32 v[180:181], v[80:81], v[248:249] op_sel_hi:[1,0]
  v_mul_f32 v180, v180, |v80|
  v_mul_f32 v181, v181, |v81|
  v_cvt_pk_bf16_f32 v136, v180, v181
  v_pk_max_i16 v136, v136, 0
  v_pk_mul_f32 v[182:183], v[82:83], v[248:249] op_sel_hi:[1,0]
  v_mul_f32 v182, v182, |v82|
  v_mul_f32 v183, v183, |v83|
  v_cvt_pk_bf16_f32 v137, v182, v183
  v_pk_max_i16 v137, v137, 0
  v_pk_mul_f32 v[180:181], v[84:85], v[248:249] op_sel_hi:[1,0]
  v_mul_f32 v180, v180, |v84|
  v_mul_f32 v181, v181, |v85|
  v_cvt_pk_bf16_f32 v138, v180, v181
  v_pk_max_i16 v138, v138, 0
  v_pk_mul_f32 v[182:183], v[86:87], v[248:249] op_sel_hi:[1,0]
  v_mul_f32 v182, v182, |v86|
  v_mul_f32 v183, v183, |v87|
  v_cvt_pk_bf16_f32 v139, v182, v183
  v_pk_max_i16 v139, v139, 0
  s_waitcnt vmcnt(12)
  ds_read_b64_tr_b16 a[80:81], v12 offset:0
  ds_read_b64_tr_b16 a[82:83], v12 offset:1024
  ds_read_b64_tr_b16 a[84:85], v13 offset:0
  ds_read_b64_tr_b16 a[86:87], v13 offset:1024
  buffer_store_dwordx4 v[136:139], v11, s[68:71], s34 offen offset:0 sc1
  v_pk_mul_f32 v[180:181], v[88:89], v[248:249] op_sel_hi:[1,0]
  v_mul_f32 v180, v180, |v88|
  v_mul_f32 v181, v181, |v89|
  v_cvt_pk_bf16_f32 v140, v180, v181
  v_pk_max_i16 v140, v140, 0
  v_pk_mul_f32 v[182:183], v[90:91], v[248:249] op_sel_hi:[1,0]
  v_mul_f32 v182, v182, |v90|
  v_mul_f32 v183, v183, |v91|
  v_cvt_pk_bf16_f32 v141, v182, v183
  v_pk_max_i16 v141, v141, 0
  v_pk_mul_f32 v[180:181], v[92:93], v[248:249] op_sel_hi:[1,0]
  v_mul_f32 v180, v180, |v92|
  v_mul_f32 v181, v181, |v93|
  v_cvt_pk_bf16_f32 v142, v180, v181
  v_pk_max_i16 v142, v142, 0
  v_pk_mul_f32 v[182:183], v[94:95], v[248:249] op_sel_hi:[1,0]
  v_mul_f32 v182, v182, |v94|
  v_mul_f32 v183, v183, |v95|
  v_cvt_pk_bf16_f32 v143, v182, v183
  ds_read_b64_tr_b16 a[88:89], v12 offset:2048
  ds_read_b64_tr_b16 a[90:91], v12 offset:3072
  ds_read_b64_tr_b16 a[92:93], v13 offset:2048
  ds_read_b64_tr_b16 a[94:95], v13 offset:3072
  v_pk_max_i16 v143, v143, 0
  buffer_store_dwordx4 v[140:143], v11, s[68:71], s34 offen offset:1024 sc1
  s_lshl_b32 s92, s76, 1
  v_add_u32 v182, s92, v160
  v_lshlrev_b32 v183, 4, v182
  v_cvt_f32_u32 v183, v183
  v_mul_f32 v180, v183, v170
  s_add_u32 m0, s36, 16384
  s_mov_b32 s98, 262144
  buffer_load_dwordx4 v176, s[64:67], s98 offen offset:0 lds
  v_mul_f32 v181, v183, v171
  v_exp_f32 v180, v180
  v_fract_f32 v181, v181
  v_cos_f32 v166, v181
  v_sin_f32_e64 v167, v181
  buffer_load_dwordx4 v177, s[64:67], s98 offen offset:1024 lds
  v_mul_f32 v166, v166, v180
  v_mul_f32 v167, v167, v180
  s_sub_i32 s92, s77, 2
  v_lshlrev_b32 v183, 1, v182
  v_sub_u32_e64 v183, s92, v183
  buffer_load_dwordx4 v178, s[64:67], s98 offen offset:2048 lds
  v_cmp_le_i32 s[28:29], 0, v183
  v_max_i32 v183, 0, v183
  v_lshlrev_b32 v183, 7, v183
  v_cvt_f32_u32 v183, v183
  v_mul_f32 v180, v183, v170
  buffer_load_dwordx4 v179, s[64:67], s98 offen offset:3072 lds
  v_mul_f32 v181, v183, v171
  v_exp_f32 v180, v180
  v_fract_f32 v181, v181
  v_cos_f32 v172, v181
  v_sin_f32_e64 v173, v181
  s_add_u32 m0, s36, 32768
  s_mov_b32 s98, 294912
  buffer_load_dwordx4 v176, s[64:67], s98 offen offset:0 lds
  v_mul_f32 v172, v172, v180
  v_mul_f32 v173, v173, v180
  s_sub_i32 s92, s77, 1
  v_lshlrev_b32 v183, 1, v182
  v_sub_u32_e64 v183, s92, v183
  buffer_load_dwordx4 v177, s[64:67], s98 offen offset:1024 lds
  v_cmp_le_i32 s[18:19], 0, v183
  v_max_i32 v183, 0, v183
  v_lshlrev_b32 v183, 7, v183
  v_cvt_f32_u32 v183, v183
  v_mul_f32 v180, v183, v170
  buffer_load_dwordx4 v178, s[64:67], s98 offen offset:2048 lds
  v_mul_f32 v181, v183, v171
  v_exp_f32 v180, v180
  v_fract_f32 v181, v181
  v_cos_f32 v170, v181
  v_sin_f32_e64 v171, v181
  buffer_load_dwordx4 v179, s[64:67], s98 offen offset:3072 lds
  v_mul_f32 v170, v170, v180
  v_mul_f32_e64 v171, v171, v180
  s_lshl_b32 s92, s76, 15
  v_lshl_add_u32 v14, v160, 14, v14
  v_add_u32 v14, s92, v14
  s_waitcnt vmcnt(18)
  ds_read_b64_tr_b16 a[96:97], v12 offset:4096
  ds_read_b64_tr_b16 a[98:99], v12 offset:5120
  ds_read_b64_tr_b16 a[100:101], v13 offset:4096
  ds_read_b64_tr_b16 a[102:103], v13 offset:5120
  v_add_u32 v9, 0x2000, v14
  v_bfrev_b32 v180, 1
  v_cndmask_b32 v14, v180, v14, s[18:19]
  v_cndmask_b32 v9, v180, v9, s[28:29]
  s_lshl_b32 s91, s90, 7
  ds_read_b64_tr_b16 a[104:105], v12 offset:6144
  ds_read_b64_tr_b16 a[106:107], v12 offset:7168
  ds_read_b64_tr_b16 a[108:109], v13 offset:6144
  ds_read_b64_tr_b16 a[110:111], v13 offset:7168
  s_lshl_b32 s92, s78, 3
  s_add_u32 s91, s91, s92
  s_add_u32 s91, s91, 262144
  v_mov_b32 v108, 0
  s_lshl_b32 s89, s79, 8
  s_add_u32 m0, s82, 16384
  s_mov_b32 s98, 327680
  buffer_load_dwordx4 v176, s[64:67], s98 offen offset:0 lds
  s_add_u32 s89, s89, 262144
  v_lshl_add_u32 v109, v10, 3, s89
  s_add_u32 s92, s36, 32768
  v_bfe_u32 v180, v0, 1, 2
  v_lshlrev_b32_e64 v181, 1, v160
  buffer_load_dwordx4 v177, s[64:67], s98 offen offset:1024 lds
  v_xor_b32 v180, v180, v181
  v_lshlrev_b32 v180, 4, v180
  v_lshl_add_u32 v180, v10, 6, v180
  v_add_u32 v112, s92, v180
  v_xor_b32 v113, 16, v112
  buffer_load_dwordx4 v178, s[64:67], s98 offen offset:2048 lds
  v_and_b32 v180, 1, v0
  v_lshlrev_b32 v180, 5, v180
  v_and_b32 v181, 16, v0
  v_or_b32 v180, v180, v181
  v_and_b32_e64 v181, 2, v0
  buffer_load_dwordx4 v179, s[64:67], s98 offen offset:3072 lds
  v_lshl_or_b32 v180, v181, 2, v180
  v_and_b32 v181, 8, v0
  v_lshlrev_b32 v181, 1, v181
  v_xor_b32_e64 v180, v180, v181
  v_bfe_u32 v181, v0, 2, 2
  s_waitcnt vmcnt(18)
  ds_read_b64_tr_b16 a[112:113], v6 offset:0
  ds_read_b64_tr_b16 a[114:115], v6 offset:1024
  ds_read_b64_tr_b16 a[116:117], v7 offset:0
  ds_read_b64_tr_b16 a[118:119], v7 offset:1024
  v_lshl_add_u32 v181, v160, 3, v181
  v_lshl_add_u32 v180, v181, 6, v180
  v_add_u32 v114, s92, v180
  v_xor_b32_e64 v115, 32, v114
  v_bfe_u32 v180, v0, 1, 3
  ds_read_b64_tr_b16 a[120:121], v6 offset:2048
  ds_read_b64_tr_b16 a[122:123], v6 offset:3072
  ds_read_b64_tr_b16 a[124:125], v7 offset:2048
  ds_read_b64_tr_b16 a[126:127], v7 offset:3072
  v_xor_b32 v180, v180, v160
  v_lshlrev_b32 v181, 7, v10
  v_xor_b32_e64 v182, 0, v180
  v_lshl_add_u32 v182, v182, 4, v181
  v_add_u32_e64 v144, s82, v182
  s_add_u32 m0, s82, 20480
  s_mov_b32 s98, 0
  buffer_load_dwordx4 v2, s[56:59], s98 offen offset:0 lds
  v_add_u32 v148, s36, v182
  v_xor_b32_e64 v182, 2, v180
  v_lshl_add_u32 v182, v182, 4, v181
  v_add_u32 v145, s82, v182
  v_add_u32 v149, s36, v182
  buffer_load_dwordx4 v3, s[56:59], s98 offen offset:1024 lds
  v_xor_b32_e64 v182, 4, v180
  v_lshl_add_u32 v182, v182, 4, v181
  v_add_u32 v146, s82, v182
  v_add_u32 v150, s36, v182
  v_xor_b32_e64 v182, 6, v180
  buffer_load_dwordx4 v4, s[56:59], s98 offen offset:2048 lds
  v_lshl_add_u32 v182, v182, 4, v181
  v_add_u32 v147, s82, v182
  v_add_u32 v151, s36, v182
  s_mul_i32 s89, s79, 307456
  s_add_u32 s89, s89, 1048576
  buffer_load_dwordx4 v5, s[56:59], s98 offen offset:3072 lds
  v_add_u32_e64 v116, s89, v11
  v_add_u32 v117, 153728, v116
  s_lshl_b32 s87, s78, 12
  s_add_u32 s87, s87, s97
  s_add_u32 s87, s87, 88064
  s_waitcnt lgkmcnt(15)
  s_add_u32 m0, s82, 8192
  s_mov_b32 s98, 32768
  buffer_load_dwordx4 v2, s[56:59], s98 offen offset:0 lds
  buffer_load_dwordx4 v3, s[56:59], s98 offen offset:1024 lds
  buffer_load_dwordx4 v4, s[56:59], s98 offen offset:2048 lds
  buffer_load_dwordx4 v5, s[56:59], s98 offen offset:3072 lds
  buffer_load_dwordx4 v[248:251], v14, s[68:71], 0 offen sc1
  buffer_load_dwordx4 v[252:255], v9, s[68:71], 0 offen sc1
  s_waitcnt vmcnt(22)
  s_mov_b64 exec, 1
  buffer_store_dwordx2 v[106:107], v108, s[68:71], s91 offen sc1
  s_mov_b64 exec, -1
  s_waitcnt vmcnt(19)
  ds_read_b64_tr_b16 a[128:129], v6 offset:16384
  ds_read_b64_tr_b16 a[130:131], v6 offset:17408
  ds_read_b64_tr_b16 a[132:133], v7 offset:16384
  ds_read_b64_tr_b16 a[134:135], v7 offset:17408
  ds_read_b64_tr_b16 a[136:137], v6 offset:18432
  ds_read_b64_tr_b16 a[138:139], v6 offset:19456
  ds_read_b64_tr_b16 a[140:141], v7 offset:18432
  ds_read_b64_tr_b16 a[142:143], v7 offset:19456
  s_waitcnt vmcnt(15)
  ds_read_b64_tr_b16 a[144:145], v6 offset:32768
  ds_read_b64_tr_b16 a[146:147], v6 offset:33792
  ds_read_b64_tr_b16 a[148:149], v7 offset:32768
  ds_read_b64_tr_b16 a[150:151], v7 offset:33792
  ds_read_b64_tr_b16 a[152:153], v6 offset:34816
  ds_read_b64_tr_b16 a[154:155], v6 offset:35840
  ds_read_b64_tr_b16 a[156:157], v7 offset:34816
  ds_read_b64_tr_b16 a[158:159], v7 offset:35840
  s_add_u32 m0, s82, 12288
  s_mov_b32 s98, 0
  buffer_load_dwordx4 v2, s[60:63], s98 offen offset:0 lds
  buffer_load_dwordx4 v3, s[60:63], s98 offen offset:1024 lds
  buffer_load_dwordx4 v4, s[60:63], s98 offen offset:2048 lds
  buffer_load_dwordx4 v5, s[60:63], s98 offen offset:3072 lds
  s_add_u32 m0, s82, 0
  s_mov_b32 s98, 32768
  buffer_load_dwordx4 v2, s[60:63], s98 offen offset:0 lds
  buffer_load_dwordx4 v3, s[60:63], s98 offen offset:1024 lds
  buffer_load_dwordx4 v4, s[60:63], s98 offen offset:2048 lds
  buffer_load_dwordx4 v5, s[60:63], s98 offen offset:3072 lds
  s_waitcnt lgkmcnt(15)
  s_add_u32 m0, s82, 4096
  s_mov_b32 s98, 128
  buffer_load_dwordx4 v2, s[56:59], s98 offen offset:0 lds
  buffer_load_dwordx4 v3, s[56:59], s98 offen offset:1024 lds
  buffer_load_dwordx4 v4, s[56:59], s98 offen offset:2048 lds
  buffer_load_dwordx4 v5, s[56:59], s98 offen offset:3072 lds
  s_waitcnt vmcnt(13)
  v_cmp_eq_u32_e64 vcc, s84, v250
  v_cmp_eq_u32 s[22:23], s85, v251
  v_cmp_eq_u32 s[24:25], s84, v254
  v_cmp_eq_u32 s[26:27], s85, v255
  s_and_b64 vcc, vcc, s[22:23]
  s_orn2_b64 vcc, vcc, s[18:19]
  s_and_b64 s[24:25], s[24:25], s[26:27]
  s_orn2_b64 s[24:25], s[24:25], s[28:29]
  s_and_b64 vcc, vcc, s[24:25]
  s_cmp_eq_u64 vcc, -1
  s_cbranch_scc1 L_gat_ok
  s_mov_b32 s94, 0x40000
L_gat_spin:
  s_sleep 1
  buffer_load_dwordx4 v[248:251], v14, s[68:71], 0 offen sc1
  buffer_load_dwordx4 v[252:255], v9, s[68:71], 0 offen sc1
  s_waitcnt vmcnt(0) lgkmcnt(0)
  v_cmp_eq_u32 vcc, s84, v250
  v_cmp_eq_u32 s[22:23], s85, v251
  v_cmp_eq_u32 s[24:25], s84, v254
  v_cmp_eq_u32 s[26:27], s85, v255
  s_and_b64 vcc, vcc, s[22:23]
  s_orn2_b64 vcc, vcc, s[18:19]
  s_and_b64 s[24:25], s[24:25], s[26:27]
  s_orn2_b64 s[24:25], s[24:25], s[28:29]
  s_and_b64 vcc, vcc, s[24:25]
  s_cmp_eq_u64 vcc, -1
  s_cbranch_scc1 L_gat_ok
  s_sub_u32 s94, s94, 1
  s_cmp_lg_u32 s94, 0
  s_cbranch_scc1 L_gat_spin
L_gat_ok:
  v_mov_b32 v16, 0
  v_mov_b32 v17, 0
  v_pk_fma_f32 v[98:99], v[248:249], v[170:171], v[16:17] op_sel:[1,1,0] op_sel_hi:[0,1,1] neg_lo:[0,1,0]
  v_pk_fma_f32 v[16:17], v[248:249], v[170:171], v[98:99] op_sel_hi:[1,0,1]
  v_pk_fma_f32 v[98:99], v[252:253], v[172:173], v[16:17] op_sel:[1,1,0] op_sel_hi:[0,1,1] neg_lo:[0,1,0]
  v_pk_fma_f32 v[16:17], v[252:253], v[172:173], v[98:99] op_sel_hi:[1,0,1]
  ds_write_b64 v8, v[16:17] offset:2048
  s_waitcnt lgkmcnt(0)
  s_barrier
  ds_read_b64 v[16:17], v15 offset:2048
  ds_read_b64 v[18:19], v15 offset:2304
  ds_read_b64 v[20:21], v15 offset:2560
  ds_read_b64 v[22:23], v15 offset:2816
  ds_read_b64 v[24:25], v15 offset:3072
  ds_read_b64 v[26:27], v15 offset:3328
  ds_read_b64 v[28:29], v15 offset:3584
  ds_read_b64 v[30:31], v15 offset:3840
  s_waitcnt lgkmcnt(0)
  v_pk_add_f32 v[16:17], v[16:17], v[18:19]
  v_pk_add_f32 v[20:21], v[20:21], v[22:23]
  v_pk_add_f32 v[24:25], v[24:25], v[26:27]
  v_pk_add_f32 v[28:29], v[28:29], v[30:31]
  v_pk_add_f32 v[16:17], v[16:17], v[20:21]
  v_pk_add_f32 v[24:25], v[24:25], v[28:29]
  v_pk_add_f32 v[16:17], v[16:17], v[24:25]
  v_pk_fma_f32 v[98:99], v[16:17], v[166:167], v[100:101] op_sel:[1,1,0] op_sel_hi:[0,1,1] neg_lo:[0,1,0]
  v_pk_fma_f32 v[16:17], v[16:17], v[166:167], v[98:99] op_sel_hi:[1,0,1]
  s_add_u32 m0, s36, 0
  s_mov_b32 s98, 32896
  buffer_load_dwordx4 v2, s[56:59], s98 offen offset:0 lds
  v_pk_fma_f32 v[200:201], v[16:17], v[162:163], v[200:201] op_sel:[1,1,0] op_sel_hi:[0,1,1] neg_lo:[0,1,0]
  v_pk_fma_f32 v[200:201], v[16:17], v[162:163], v[200:201] op_sel_hi:[1,0,1]
  v_pk_fma_f32 v[202:203], v[200:201], v[162:163], v[202:203] op_sel:[1,1,0] op_sel_hi:[0,1,1] neg_lo:[0,1,0]
  v_pk_fma_f32 v[202:203], v[200:201], v[162:163], v[202:203] op_sel_hi:[1,0,1]
  v_cvt_pk_bf16_f32 v48, v200, v202
  v_cvt_pk_bf16_f32 v56, -v201, -v203
  v_pk_fma_f32 v[204:205], v[202:203], v[162:163], v[204:205] op_sel:[1,1,0] op_sel_hi:[0,1,1] neg_lo:[0,1,0]
  v_pk_fma_f32 v[204:205], v[202:203], v[162:163], v[204:205] op_sel_hi:[1,0,1]
  v_pk_fma_f32 v[206:207], v[204:205], v[162:163], v[206:207] op_sel:[1,1,0] op_sel_hi:[0,1,1] neg_lo:[0,1,0]
  v_pk_fma_f32 v[206:207], v[204:205], v[162:163], v[206:207] op_sel_hi:[1,0,1]
  buffer_load_dwordx4 v3, s[56:59], s98 offen offset:1024 lds
  v_cvt_pk_bf16_f32 v49, v204, v206
  v_cvt_pk_bf16_f32 v57, -v205, -v207
  v_pk_fma_f32 v[208:209], v[206:207], v[162:163], v[208:209] op_sel:[1,1,0] op_sel_hi:[0,1,1] neg_lo:[0,1,0]
  v_pk_fma_f32 v[208:209], v[206:207], v[162:163], v[208:209] op_sel_hi:[1,0,1]
  v_pk_fma_f32 v[210:211], v[208:209], v[162:163], v[210:211] op_sel:[1,1,0] op_sel_hi:[0,1,1] neg_lo:[0,1,0]
  v_pk_fma_f32 v[210:211], v[208:209], v[162:163], v[210:211] op_sel_hi:[1,0,1]
  v_cvt_pk_bf16_f32 v50, v208, v210
  v_cvt_pk_bf16_f32 v58, -v209, -v211
  v_pk_fma_f32 v[212:213], v[210:211], v[162:163], v[212:213] op_sel:[1,1,0] op_sel_hi:[0,1,1] neg_lo:[0,1,0]
  v_pk_fma_f32 v[212:213], v[210:211], v[162:163], v[212:213] op_sel_hi:[1,0,1]
  buffer_load_dwordx4 v4, s[56:59], s98 offen offset:2048 lds
  v_pk_fma_f32 v[214:215], v[212:213], v[162:163], v[214:215] op_sel:[1,1,0] op_sel_hi:[0,1,1] neg_lo:[0,1,0]
  v_pk_fma_f32 v[214:215], v[212:213], v[162:163], v[214:215] op_sel_hi:[1,0,1]
  v_cvt_pk_bf16_f32 v51, v212, v214
  v_cvt_pk_bf16_f32 v59, -v213, -v215
  ds_write_b128 v112, v[48:51]
  ds_write_b128 v112, v[56:59] offset:2048
  v_pk_fma_f32 v[216:217], v[214:215], v[162:163], v[216:217] op_sel:[1,1,0] op_sel_hi:[0,1,1] neg_lo:[0,1,0]
  v_pk_fma_f32 v[216:217], v[214:215], v[162:163], v[216:217] op_sel_hi:[1,0,1]
  v_pk_fma_f32 v[218:219], v[216:217], v[162:163], v[218:219] op_sel:[1,1,0] op_sel_hi:[0,1,1] neg_lo:[0,1,0]
  buffer_load_dwordx4 v5, s[56:59], s98 offen offset:3072 lds
  v_pk_fma_f32 v[218:219], v[216:217], v[162:163], v[218:219] op_sel_hi:[1,0,1]
  v_cvt_pk_bf16_f32 v52, v216, v218
  v_cvt_pk_bf16_f32 v60, -v217, -v219
  v_pk_fma_f32 v[220:221], v[218:219], v[162:163], v[220:221] op_sel:[1,1,0] op_sel_hi:[0,1,1] neg_lo:[0,1,0]
  v_pk_fma_f32 v[220:221], v[218:219], v[162:163], v[220:221] op_sel_hi:[1,0,1]
  v_pk_fma_f32 v[222:223], v[220:221], v[162:163], v[222:223] op_sel:[1,1,0] op_sel_hi:[0,1,1] neg_lo:[0,1,0]
  v_pk_fma_f32 v[222:223], v[220:221], v[162:163], v[222:223] op_sel_hi:[1,0,1]
  v_cvt_pk_bf16_f32 v53, v220, v222
  v_cvt_pk_bf16_f32 v61, -v221, -v223
  v_pk_fma_f32 v[224:225], v[222:223], v[162:163], v[224:225] op_sel:[1,1,0] op_sel_hi:[0,1,1] neg_lo:[0,1,0]
  s_add_u32 m0, s36, 16384
  s_mov_b32 s98, 128
  buffer_load_dwordx4 v2, s[60:63], s98 offen offset:0 lds
  v_pk_fma_f32 v[224:225], v[222:223], v[162:163], v[224:225] op_sel_hi:[1,0,1]
  v_pk_fma_f32 v[226:227], v[224:225], v[162:163], v[226:227] op_sel:[1,1,0] op_sel_hi:[0,1,1] neg_lo:[0,1,0]
  v_pk_fma_f32 v[226:227], v[224:225], v[162:163], v[226:227] op_sel_hi:[1,0,1]
  v_cvt_pk_bf16_f32 v54, v224, v226
  v_cvt_pk_bf16_f32 v62, -v225, -v227
  v_pk_fma_f32 v[228:229], v[226:227], v[162:163], v[228:229] op_sel:[1,1,0] op_sel_hi:[0,1,1] neg_lo:[0,1,0]
  v_pk_fma_f32 v[228:229], v[226:227], v[162:163], v[228:229] op_sel_hi:[1,0,1]
  v_pk_fma_f32 v[230:231], v[228:229], v[162:163], v[230:231] op_sel:[1,1,0] op_sel_hi:[0,1,1] neg_lo:[0,1,0]
  v_pk_fma_f32 v[230:231], v[228:229], v[162:163], v[230:231] op_sel_hi:[1,0,1]
  v_cvt_pk_bf16_f32 v55, v228, v230
  buffer_load_dwordx4 v3, s[60:63], s98 offen offset:1024 lds
  v_cvt_pk_bf16_f32 v63, -v229, -v231
  ds_write_b128 v113, v[52:55]
  ds_write_b128 v113, v[60:63] offset:2048
  buffer_load_dwordx4 v4, s[60:63], s98 offen offset:2048 lds
  buffer_load_dwordx4 v5, s[60:63], s98 offen offset:3072 lds
  s_waitcnt lgkmcnt(0)
  ds_read_b64_tr_b16 v[64:65], v114 offset:0
  ds_read_b64_tr_b16 v[66:67], v115 offset:256
  ds_read_b64_tr_b16 v[68:69], v114 offset:1024
  ds_read_b64_tr_b16 v[70:71], v115 offset:1280
  ds_read_b64_tr_b16 v[72:73], v114 offset:2048
  ds_read_b64_tr_b16 v[74:75], v115 offset:2304
  ds_read_b64_tr_b16 v[76:77], v114 offset:3072
  ds_read_b64_tr_b16 v[78:79], v115 offset:3328
  buffer_load_dwordx2 v[110:111], v109, s[68:71], 0 offen sc1
  s_waitcnt lgkmcnt(0)
  buffer_store_dwordx4 v[64:67], v11, s[68:71], s87 offen offset:0 sc1
  buffer_store_dwordx4 v[68:71], v11, s[68:71], s87 offen offset:1024 sc1
  buffer_store_dwordx4 v[72:75], v11, s[68:71], s87 offen offset:2048 sc1
  buffer_store_dwordx4 v[76:79], v11, s[68:71], s87 offen offset:3072 sc1
  s_waitcnt vmcnt(4)
  v_cmp_eq_u32 vcc, s84, v110
  v_cmp_eq_u32 s[22:23], s85, v111
  s_nop 0
  s_and_b64 vcc, vcc, s[22:23]
  s_cmp_eq_u64 vcc, -1
  s_cbranch_scc1 L_pf_ok
  s_mov_b32 s94, 0x40000
L_pf_spin:
  s_sleep 1
  buffer_load_dwordx2 v[110:111], v109, s[68:71], 0 offen sc1
  s_waitcnt vmcnt(0) lgkmcnt(0)
  v_cmp_eq_u32_e64 vcc, s84, v110
  v_cmp_eq_u32 s[22:23], s85, v111
  s_nop 0
  s_and_b64 vcc, vcc, s[22:23]
  s_cmp_eq_u64 vcc, -1
  s_cbranch_scc1 L_pf_ok
  s_sub_u32 s94, s94, 1
  s_cmp_lg_u32 s94, 0
  s_cbranch_scc1 L_pf_spin
L_pf_ok:
  s_mul_i32 s92, s76, 22528
  buffer_load_dwordx4 a[160:163], v116, s[68:71], s92 offen offset:0 sc1
  buffer_load_dwordx4 a[164:167], v117, s[68:71], s92 offen offset:0 sc1
  buffer_load_dwordx4 a[168:171], v116, s[68:71], s92 offen offset:1024 sc1
  buffer_load_dwordx4 a[172:175], v117, s[68:71], s92 offen offset:1024 sc1
  buffer_load_dwordx4 a[176:179], v116, s[68:71], s92 offen offset:2048 sc1
  buffer_load_dwordx4 a[180:183], v117, s[68:71], s92 offen offset:2048 sc1
  buffer_load_dwordx4 a[184:187], v116, s[68:71], s92 offen offset:3072 sc1
  buffer_load_dwordx4 a[188:191], v117, s[68:71], s92 offen offset:3072 sc1
  s_add_u32 s92, s92, 4096
  buffer_load_dwordx4 a[192:195], v116, s[68:71], s92 offen offset:0 sc1
  buffer_load_dwordx4 a[196:199], v117, s[68:71], s92 offen offset:0 sc1
  buffer_load_dwordx4 a[200:203], v116, s[68:71], s92 offen offset:1024 sc1
  buffer_load_dwordx4 a[204:207], v117, s[68:71], s92 offen offset:1024 sc1
  buffer_load_dwordx4 a[208:211], v116, s[68:71], s92 offen offset:2048 sc1
  buffer_load_dwordx4 a[212:215], v117, s[68:71], s92 offen offset:2048 sc1
  s_waitcnt vmcnt(13)
  s_add_u32 s91, s91, 8192
  s_mov_b64 exec, 1
  buffer_store_dwordx2 v[106:107], v108, s[68:71], s91 offen sc1
  s_mov_b64 exec, -1
  v_mfma_f32_32x32x16_bf16 v[16:31], a[0:3], a[160:163], 0
  buffer_load_dwordx4 a[216:219], v116, s[68:71], s92 offen offset:3072 sc1
  v_mfma_f32_32x32x16_bf16 v[32:47], a[4:7], a[160:163], 0
  s_add_u32 m0, s36, 32768
  s_mov_b32 s98, 32896
  buffer_load_dwordx4 v2, s[60:63], s98 offen offset:0 lds
  s_waitcnt vmcnt(15)
  v_mfma_f32_32x32x16_bf16 v[48:63], a[0:3], a[164:167], 0
  buffer_load_dwordx4 a[220:223], v117, s[68:71], s92 offen offset:3072 sc1
  v_mfma_f32_32x32x16_bf16 v[64:79], a[4:7], a[164:167], 0
  buffer_load_dwordx4 v3, s[60:63], s98 offen offset:1024 lds
  s_waitcnt vmcnt(16)
  v_mfma_f32_32x32x16_bf16 v[16:31], a[8:11], a[168:171], v[16:31]
  s_add_u32 s92, s92, 4096
  buffer_load_dwordx4 a[224:227], v116, s[68:71], s92 offen offset:0 sc1
  v_mfma_f32_32x32x16_bf16 v[32:47], a[12:15], a[168:171], v[32:47]
  buffer_load_dwordx4 v4, s[60:63], s98 offen offset:2048 lds
  s_waitcnt vmcnt(17)
  v_mfma_f32_32x32x16_bf16 v[48:63], a[8:11], a[172:175], v[48:63]
  buffer_load_dwordx4 a[228:231], v117, s[68:71], s92 offen offset:0 sc1
  v_mfma_f32_32x32x16_bf16 v[64:79], a[12:15], a[172:175], v[64:79]
  buffer_load_dwordx4 v5, s[60:63], s98 offen offset:3072 lds
  s_lshl4_add_u32 s93, s79, s76
  s_lshl_b32 s93, s93, 2
  v_lshrrev_b32_e64 v180, 4, v0
  s_waitcnt vmcnt(18)
  v_mfma_f32_32x32x16_bf16 v[16:31], a[16:19], a[176:179], v[16:31]
  buffer_load_dwordx4 a[232:235], v116, s[68:71], s92 offen offset:1024 sc1
  v_add_u32 v181, s93, v180
  v_and_b32_e64 v182, 15, v0
  s_lshl_b32 s93, s80, 7
  v_mfma_f32_32x32x16_bf16 v[32:47], a[20:23], a[176:179], v[32:47]
  v_lshl_add_u32 v99, v182, 3, s93
  v_lshl_add_u32 v97, v181, 10, v99
  v_lshlrev_b32 v96, 1, v97
  s_waitcnt vmcnt(18)
  v_mfma_f32_32x32x16_bf16 v[48:63], a[16:19], a[180:183], v[48:63]
  buffer_load_dwordx4 a[236:239], v117, s[68:71], s92 offen offset:1024 sc1
  v_sub_u32 v98, v181, v180
  v_and_b32 v183, 12, v0
  v_lshlrev_b32_e64 v183, 2, v183
  v_mfma_f32_32x32x16_bf16 v[64:79], a[20:23], a[180:183], v[64:79]
  v_and_or_b32 v183, v0, 3, v183
  v_add_lshl_u32 v98, v98, v183, 4
  v_add_u32 v98, 327680, v98
  s_waitcnt vmcnt(18)
  v_mfma_f32_32x32x16_bf16 v[16:31], a[24:27], a[184:187], v[16:31]
  buffer_load_dwordx4 a[160:163], v116, s[68:71], s92 offen offset:2048 sc1
  buffer_load_dwordx2 v[184:185], v98, s[68:71], 0 offen sc1
  v_lshlrev_b32 v98, 2, v180
  v_mfma_f32_32x32x16_bf16 v[32:47], a[28:31], a[184:187], v[32:47]
  v_accvgpr_read_b32 v200, a240
  v_accvgpr_read_b32 v201, a241
  s_waitcnt vmcnt(19)
  v_mfma_f32_32x32x16_bf16 v[48:63], a[24:27], a[188:191], v[48:63]
  buffer_load_dwordx4 a[164:167], v117, s[68:71], s92 offen offset:2048 sc1
  v_accvgpr_read_b32 v202, a242
  v_accvgpr_read_b32 v203, a243
  v_accvgpr_read_b32 v204, a244
  v_mfma_f32_32x32x16_bf16 v[64:79], a[28:31], a[188:191], v[64:79]
  v_accvgpr_read_b32 v205, a245
  v_accvgpr_read_b32 v206, a246
  v_accvgpr_read_b32 v207, a247
  s_waitcnt vmcnt(19)
  v_mfma_f32_32x32x16_bf16 v[16:31], a[32:35], a[192:195], v[16:31]
  buffer_load_dwordx4 a[168:171], v116, s[68:71], s92 offen offset:3072 sc1
  v_accvgpr_read_b32 v216, a248
  v_accvgpr_read_b32 v217, a249
  v_accvgpr_read_b32 v218, a250
  v_mfma_f32_32x32x16_bf16 v[32:47], a[36:39], a[192:195], v[32:47]
  v_accvgpr_read_b32 v219, a251
  v_and_b32 v183, 7, v0
  v_xor_b32_e64 v183, v183, v160
  s_waitcnt vmcnt(19)
  v_mfma_f32_32x32x16_bf16 v[48:63], a[32:35], a[196:199], v[48:63]
  buffer_load_dwordx4 a[172:175], v117, s[68:71], s92 offen offset:3072 sc1
  v_lshlrev_b32_e64 v183, 4, v183
  v_lshl_add_u32 v183, v10, 8, v183
  v_add_u32_e64 v183, s82, v183
  v_mfma_f32_32x32x16_bf16 v[64:79], a[36:39], a[196:199], v[64:79]
  v_xor_b32 v112, 0, v183
  v_xor_b32 v113, 32, v183
  v_xor_b32 v114, 64, v183
  s_waitcnt vmcnt(19)
  v_mfma_f32_32x32x16_bf16 v[16:31], a[40:43], a[200:203], v[16:31]
  s_add_u32 s92, s92, 4096
  buffer_load_dwordx4 a[176:179], v116, s[68:71], s92 offen offset:0 sc1
  v_xor_b32 v115, 96, v183
  v_xor_b32 v182, v182, v180
  v_lshlrev_b32 v182, 4, v182
  v_mfma_f32_32x32x16_bf16 v[32:47], a[44:47], a[200:203], v[32:47]
  v_lshl_add_u32 v182, v180, 8, v182
  s_lshl_b32 s93, s76, 11
  v_add_u32_e64 v102, s93, v182
  s_waitcnt vmcnt(19)
  v_mfma_f32_32x32x16_bf16 v[48:63], a[40:43], a[204:207], v[48:63]
  v_xor_b32 v103, 1088, v102
  v_add_u32 v104, 73728, v102
  v_add_u32 v105, 73728, v103
  v_mfma_f32_32x32x16_bf16 v[64:79], a[44:47], a[204:207], v[64:79]
  s_waitcnt vmcnt(18)
  v_mfma_f32_32x32x16_bf16 v[16:31], a[48:51], a[208:211], v[16:31]
  buffer_load_dwordx4 a[180:183], v117, s[68:71], s92 offen offset:0 sc1
  v_mfma_f32_32x32x16_bf16 v[32:47], a[52:55], a[208:211], v[32:47]
  s_waitcnt vmcnt(18)
  v_mfma_f32_32x32x16_bf16 v[48:63], a[48:51], a[212:215], v[48:63]
  buffer_load_dwordx4 a[184:187], v116, s[68:71], s92 offen offset:1024 sc1
  v_mfma_f32_32x32x16_bf16 v[64:79], a[52:55], a[212:215], v[64:79]
  s_waitcnt vmcnt(17)
  v_mfma_f32_32x32x16_bf16 v[16:31], a[56:59], a[216:219], v[16:31]
  buffer_load_dwordx4 a[188:191], v117, s[68:71], s92 offen offset:1024 sc1
  v_mfma_f32_32x32x16_bf16 v[32:47], a[60:63], a[216:219], v[32:47]
  s_waitcnt vmcnt(16)
  v_mfma_f32_32x32x16_bf16 v[48:63], a[56:59], a[220:223], v[48:63]
  buffer_load_dwordx4 a[192:195], v116, s[68:71], s92 offen offset:2048 sc1
  v_mfma_f32_32x32x16_bf16 v[64:79], a[60:63], a[220:223], v[64:79]
  s_waitcnt vmcnt(15)
  v_mfma_f32_32x32x16_bf16 v[16:31], a[64:67], a[224:227], v[16:31]
  buffer_load_dwordx4 a[196:199], v117, s[68:71], s92 offen offset:2048 sc1
  v_mfma_f32_32x32x16_bf16 v[32:47], a[68:71], a[224:227], v[32:47]
  s_waitcnt vmcnt(14)
  v_mfma_f32_32x32x16_bf16 v[48:63], a[64:67], a[228:231], v[48:63]
  buffer_load_dwordx4 a[200:203], v116, s[68:71], s92 offen offset:3072 sc1
  s_waitcnt vmcnt(10)
  ds_bpermute_b32 v208, v98, v184 offset:0
  ds_bpermute_b32 v209, v98, v185 offset:0
  ds_bpermute_b32 v210, v98, v184 offset:16
  v_mfma_f32_32x32x16_bf16 v[64:79], a[68:71], a[228:231], v[64:79]
  ds_bpermute_b32 v211, v98, v185 offset:16
  ds_bpermute_b32 v212, v98, v184 offset:32
  ds_bpermute_b32 v213, v98, v185 offset:32
  ds_bpermute_b32 v214, v98, v184 offset:48
  v_mfma_f32_32x32x16_bf16 v[16:31], a[72:75], a[232:235], v[16:31]
  buffer_load_dwordx4 a[204:207], v117, s[68:71], s92 offen offset:3072 sc1
  ds_bpermute_b32 v215, v98, v185 offset:48
  v_lshlrev_b32 v220, 16, v216
  v_and_b32 v221, 0xffff0000, v216
  v_lshlrev_b32_e64 v222, 16, v217
  v_mfma_f32_32x32x16_bf16 v[32:47], a[76:79], a[232:235], v[32:47]
  v_and_b32 v223, 0xffff0000, v217
  v_lshlrev_b32_e64 v224, 16, v218
  v_and_b32 v225, 0xffff0000, v218
  v_lshlrev_b32_e64 v226, 16, v219
  v_mfma_f32_32x32x16_bf16 v[48:63], a[72:75], a[236:239], v[48:63]
  s_add_u32 s92, s92, 4096
  buffer_load_dwordx4 a[208:211], v116, s[68:71], s92 offen offset:0 sc1
  v_and_b32 v227, 0xffff0000, v219
  s_waitcnt lgkmcnt(0)
  v_lshlrev_b32 v208, 16, v208
  v_lshlrev_b32_e64 v80, 16, v200
  v_mfma_f32_32x32x16_bf16 v[64:79], a[76:79], a[236:239], v[64:79]
  v_and_b32 v81, 0xffff0000, v200
  v_lshlrev_b32_e64 v82, 16, v201
  v_and_b32 v83, 0xffff0000, v201
  v_add_f32_e64 v180, v80, v208
  v_mfma_f32_32x32x16_bf16 v[16:31], a[80:83], a[160:163], v[16:31]
  buffer_load_dwordx4 a[212:215], v117, s[68:71], s92 offen offset:0 sc1
  v_add_f32 v80, v80, v224
  v_mul_f32 v180, v180, v209
  v_fmac_f32 v80, v180, v220
  v_add_f32 v180, v81, v208
  v_mfma_f32_32x32x16_bf16 v[32:47], a[84:87], a[160:163], v[32:47]
  v_add_f32 v81, v81, v225
  v_mul_f32 v180, v180, v209
  v_fmac_f32 v81, v180, v221
  v_add_f32_e64 v180, v82, v208
  s_waitcnt vmcnt(12)
  v_mfma_f32_32x32x16_bf16 v[48:63], a[80:83], a[164:167], v[48:63]
  buffer_load_dwordx4 a[216:219], v116, s[68:71], s92 offen offset:1024 sc1
  v_add_f32 v82, v82, v226
  v_mul_f32 v180, v180, v209
  v_fmac_f32 v82, v180, v222
  v_add_f32 v180, v83, v208
  v_mfma_f32_32x32x16_bf16 v[64:79], a[84:87], a[164:167], v[64:79]
  v_add_f32 v83, v83, v227
  v_mul_f32 v180, v180, v209
  v_fmac_f32 v83, v180, v223
  v_lshlrev_b32_e64 v210, 16, v210
  s_waitcnt vmcnt(12)
  v_mfma_f32_32x32x16_bf16 v[16:31], a[88:91], a[168:171], v[16:31]
  v_lshlrev_b32_e64 v84, 16, v202
  v_and_b32 v85, 0xffff0000, v202
  v_lshlrev_b32_e64 v86, 16, v203
  v_and_b32 v87, 0xffff0000, v203
  v_mfma_f32_32x32x16_bf16 v[32:47], a[92:95], a[168:171], v[32:47]
  v_add_f32 v180, v84, v210
  v_add_f32 v84, v84, v224
  v_mul_f32_e64 v180, v180, v211
  v_fmac_f32 v84, v180, v220
  s_waitcnt vmcnt(11)
  v_mfma_f32_32x32x16_bf16 v[48:63], a[88:91], a[172:175], v[48:63]
  buffer_load_dwordx4 a[220:223], v117, s[68:71], s92 offen offset:1024 sc1
  v_add_f32 v180, v85, v210
  v_add_f32 v85, v85, v225
  v_mul_f32 v180, v180, v211
  v_fmac_f32 v85, v180, v221
  v_mfma_f32_32x32x16_bf16 v[64:79], a[92:95], a[172:175], v[64:79]
  v_add_f32 v180, v86, v210
  v_add_f32 v86, v86, v226
  v_mul_f32_e64 v180, v180, v211
  v_fmac_f32 v86, v180, v222
  s_waitcnt vmcnt(11)
  v_mfma_f32_32x32x16_bf16 v[16:31], a[96:99], a[176:179], v[16:31]
  buffer_load_dwordx4 a[224:227], v116, s[68:71], s92 offen offset:2048 sc1
  s_movk_i32 s89, 0x2000
  buffer_load_dwordx2 v[110:111], v109, s[68:71], s89 offen sc1
  v_add_f32 v180, v87, v210
  v_add_f32 v87, v87, v227
  v_mul_f32_e64 v180, v180, v211
  v_fmac_f32 v87, v180, v223
  v_mfma_f32_32x32x16_bf16 v[32:47], a[100:103], a[176:179], v[32:47]
  v_lshlrev_b32 v212, 16, v212
  v_lshlrev_b32 v88, 16, v204
  v_and_b32 v89, 0xffff0000, v204
  v_lshlrev_b32 v90, 16, v205
  s_waitcnt vmcnt(12)
  v_mfma_f32_32x32x16_bf16 v[48:63], a[96:99], a[180:183], v[48:63]
  buffer_load_dwordx4 a[228:231], v117, s[68:71], s92 offen offset:2048 sc1
  v_and_b32 v91, 0xffff0000, v205
  v_add_f32 v180, v88, v212
  v_add_f32 v88, v88, v224
  v_mul_f32_e64 v180, v180, v213
  v_mfma_f32_32x32x16_bf16 v[64:79], a[100:103], a[180:183], v[64:79]
  v_fmac_f32 v88, v180, v220
  v_add_f32 v180, v89, v212
  v_add_f32 v89, v89, v225
  v_mul_f32_e64 v180, v180, v213
  s_waitcnt vmcnt(12)
  v_mfma_f32_32x32x16_bf16 v[16:31], a[104:107], a[184:187], v[16:31]
  buffer_load_dwordx4 a[232:235], v116, s[68:71], s92 offen offset:3072 sc1
  v_fmac_f32 v89, v180, v221
  v_add_f32 v180, v90, v212
  v_add_f32 v90, v90, v226
  v_mul_f32 v180, v180, v213
  v_mfma_f32_32x32x16_bf16 v[32:47], a[108:111], a[184:187], v[32:47]
  v_fmac_f32 v90, v180, v222
  v_add_f32 v180, v91, v212
  v_add_f32 v91, v91, v227
  v_mul_f32_e64 v180, v180, v213
  s_waitcnt vmcnt(12)
  v_mfma_f32_32x32x16_bf16 v[48:63], a[104:107], a[188:191], v[48:63]
  buffer_load_dwordx4 a[236:239], v117, s[68:71], s92 offen offset:3072 sc1
  v_fmac_f32 v91, v180, v223
  v_lshlrev_b32 v214, 16, v214
  v_lshlrev_b32_e64 v92, 16, v206
  v_and_b32 v93, 0xffff0000, v206
  v_mfma_f32_32x32x16_bf16 v[64:79], a[108:111], a[188:191], v[64:79]
  v_lshlrev_b32_e64 v94, 16, v207
  v_and_b32 v95, 0xffff0000, v207
  v_add_f32 v180, v92, v214
  v_add_f32_e64 v92, v92, v224
  s_waitcnt vmcnt(12)
  v_mfma_f32_32x32x16_bf16 v[16:31], a[112:115], a[192:195], v[16:31]
  s_add_u32 s92, s92, 4096
  s_cmp_eq_u32 s76, 3
  s_cselect_b32 s92, 0x80000000, s92
  buffer_load_dwordx4 a[160:163], v116, s[68:71], s92 offen offset:0 sc1
  v_mul_f32 v180, v180, v215
  v_fmac_f32 v92, v180, v220
  v_add_f32 v180, v93, v214
  v_add_f32_e64 v93, v93, v225
  v_mfma_f32_32x32x16_bf16 v[32:47], a[116:119], a[192:195], v[32:47]
  v_mul_f32 v180, v180, v215
  v_fmac_f32 v93, v180, v221
  v_add_f32 v180, v94, v214
  v_add_f32_e64 v94, v94, v226
  s_waitcnt vmcnt(12)
  v_mfma_f32_32x32x16_bf16 v[48:63], a[112:115], a[196:199], v[48:63]
  buffer_load_dwordx4 a[164:167], v117, s[68:71], s92 offen offset:0 sc1
  v_mul_f32 v180, v180, v215
  v_fmac_f32 v94, v180, v222
  v_add_f32 v180, v95, v214
  v_add_f32 v95, v95, v227
  v_mfma_f32_32x32x16_bf16 v[64:79], a[116:119], a[196:199], v[64:79]
  v_mul_f32_e64 v180, v180, v215
  v_fmac_f32 v95, v180, v223
  s_waitcnt vmcnt(12)
  v_mfma_f32_32x32x16_bf16 v[16:31], a[120:123], a[200:203], v[16:31]
  buffer_load_dwordx4 a[168:171], v116, s[68:71], s92 offen offset:1024 sc1
  v_mfma_f32_32x32x16_bf16 v[32:47], a[124:127], a[200:203], v[32:47]
  s_waitcnt vmcnt(12)
  v_mfma_f32_32x32x16_bf16 v[48:63], a[120:123], a[204:207], v[48:63]
  buffer_load_dwordx4 a[172:175], v117, s[68:71], s92 offen offset:1024 sc1
  v_mfma_f32_32x32x16_bf16 v[64:79], a[124:127], a[204:207], v[64:79]
  s_waitcnt vmcnt(7)
  v_cmp_eq_u32_e64 vcc, s84, v110
  v_cmp_eq_u32 s[22:23], s85, v111
  s_nop 0
  s_and_b64 vcc, vcc, s[22:23]
  s_cmp_eq_u64 vcc, -1
  s_cbranch_scc1 L_ps_ok
  s_mov_b32 s94, 0x40000
L_ps_spin:
  s_sleep 1
  buffer_load_dwordx2 v[110:111], v109, s[68:71], s89 offen sc1
  s_waitcnt vmcnt(0) lgkmcnt(0)
  v_cmp_eq_u32_e64 vcc, s84, v110
  v_cmp_eq_u32 s[22:23], s85, v111
  s_nop 0
  s_and_b64 vcc, vcc, s[22:23]
  s_cmp_eq_u64 vcc, -1
  s_cbranch_scc1 L_ps_ok
  s_sub_u32 s94, s94, 1
  s_cmp_lg_u32 s94, 0
  s_cbranch_scc1 L_ps_spin
L_ps_ok:
  s_lshl_b32 s88, s79, 8
  s_lshl_b32 s94, s80, 2
  s_or_b32 s88, s88, s94
  s_or_b32 s88, s88, s76
  s_cmp_lg_u32 s88, 7936
  s_cbranch_scc1 L_noadv
  s_mov_b64 exec, 1
  buffer_store_dword v106, v108, s[68:71], 0 offen sc1
  s_mov_b64 exec, -1
L_noadv:
  v_mfma_f32_32x32x16_bf16 v[16:31], a[128:131], a[208:211], v[16:31]
  s_lshl_b32 s92, s76, 14
  s_add_u32 s92, s92, 88064
  buffer_load_dwordx4 a[176:179], v116, s[68:71], s92 offen offset:0 sc1
  v_mfma_f32_32x32x16_bf16 v[32:47], a[132:135], a[208:211], v[32:47]
  v_mfma_f32_32x32x16_bf16 v[48:63], a[128:131], a[212:215], v[48:63]
  v_mfma_f32_32x32x16_bf16 v[64:79], a[132:135], a[212:215], v[64:79]
  v_mfma_f32_32x32x16_bf16 v[16:31], a[136:139], a[216:219], v[16:31]
  buffer_load_dwordx4 a[180:183], v116, s[68:71], s92 offen offset:1024 sc1
  v_mfma_f32_32x32x16_bf16 v[32:47], a[140:143], a[216:219], v[32:47]
  v_mfma_f32_32x32x16_bf16 v[48:63], a[136:139], a[220:223], v[48:63]
  buffer_load_dwordx4 a[184:187], v116, s[68:71], s92 offen offset:2048 sc1
  v_mfma_f32_32x32x16_bf16 v[64:79], a[140:143], a[220:223], v[64:79]
  v_mfma_f32_32x32x16_bf16 v[16:31], a[144:147], a[224:227], v[16:31]
  buffer_load_dwordx4 a[188:191], v116, s[68:71], s92 offen offset:3072 sc1
  v_mfma_f32_32x32x16_bf16 v[32:47], a[148:151], a[224:227], v[32:47]
  ds_read_b64_tr_b16 v[120:121], v12 offset:16384
  ds_read_b64_tr_b16 v[122:123], v12 offset:17408
  ds_read_b64_tr_b16 v[124:125], v13 offset:16384
  ds_read_b64_tr_b16 v[126:127], v13 offset:17408
  s_waitcnt vmcnt(10)
  v_mfma_f32_32x32x16_bf16 v[48:63], a[144:147], a[228:231], v[48:63]
  s_add_u32 s92, s92, 4096
  buffer_load_dwordx4 a[192:195], v116, s[68:71], s92 offen offset:0 sc1
  v_mfma_f32_32x32x16_bf16 v[64:79], a[148:151], a[228:231], v[64:79]
  ds_read_b64_tr_b16 v[128:129], v12 offset:18432
  ds_read_b64_tr_b16 v[130:131], v12 offset:19456
  ds_read_b64_tr_b16 v[132:133], v13 offset:18432
  ds_read_b64_tr_b16 v[134:135], v13 offset:19456
  s_waitcnt vmcnt(10)
  v_mfma_f32_32x32x16_bf16 v[16:31], a[152:155], a[232:235], v[16:31]
  buffer_load_dwordx4 a[196:199], v116, s[68:71], s92 offen offset:1024 sc1
  v_mfma_f32_32x32x16_bf16 v[32:47], a[156:159], a[232:235], v[32:47]
  s_waitcnt vmcnt(10)
  v_mfma_f32_32x32x16_bf16 v[48:63], a[152:155], a[236:239], v[48:63]
  buffer_load_dwordx4 a[200:203], v116, s[68:71], s92 offen offset:2048 sc1
  v_mfma_f32_32x32x16_bf16 v[64:79], a[156:159], a[236:239], v[64:79]
  s_waitcnt vmcnt(10) lgkmcnt(4)
  v_mfma_f32_32x32x16_bf16 v[16:31], v[120:123], a[160:163], v[16:31]
  buffer_load_dwordx4 a[204:207], v116, s[68:71], s92 offen offset:3072 sc1
  v_mfma_f32_32x32x16_bf16 v[32:47], v[124:127], a[160:163], v[32:47]
  s_waitcnt vmcnt(10)
  v_mfma_f32_32x32x16_bf16 v[48:63], v[120:123], a[164:167], v[48:63]
  s_add_u32 s92, s92, 4096
  buffer_load_dwordx4 a[208:211], v116, s[68:71], s92 offen offset:0 sc1
  v_mfma_f32_32x32x16_bf16 v[64:79], v[124:127], a[164:167], v[64:79]
  ds_read_b128 a[0:3], v144 offset:20480
  ds_read_b128 a[4:7], v144 offset:8192
  s_waitcnt vmcnt(10) lgkmcnt(2)
  v_mfma_f32_32x32x16_bf16 v[16:31], v[128:131], a[168:171], v[16:31]
  buffer_load_dwordx4 a[212:215], v116, s[68:71], s92 offen offset:1024 sc1
  v_mfma_f32_32x32x16_bf16 v[32:47], v[132:135], a[168:171], v[32:47]
  ds_read_b128 a[8:11], v145 offset:20480
  ds_read_b128 a[12:15], v145 offset:8192
  s_waitcnt vmcnt(10)
  v_mfma_f32_32x32x16_bf16 v[48:63], v[128:131], a[172:175], v[48:63]
  buffer_load_dwordx4 a[216:219], v116, s[68:71], s92 offen offset:2048 sc1
  v_mfma_f32_32x32x16_bf16 v[64:79], v[132:135], a[172:175], v[64:79]
  ds_read_b128 a[16:19], v144 offset:12288
  ds_read_b128 a[20:23], v144 offset:0
  s_waitcnt vmcnt(10) lgkmcnt(4)
  v_mfma_f32_32x32x16_bf16 v[16:31], a[0:3], a[176:179], v[16:31]
  buffer_load_dwordx4 a[220:223], v116, s[68:71], s92 offen offset:3072 sc1
  v_mfma_f32_32x32x16_bf16 v[32:47], a[4:7], a[176:179], v[32:47]
  ds_read_b128 a[24:27], v145 offset:12288
  ds_read_b128 a[28:31], v145 offset:0
  s_waitcnt vmcnt(10) lgkmcnt(4)
  v_mfma_f32_32x32x16_bf16 v[16:31], a[8:11], a[180:183], v[16:31]
  v_mfma_f32_32x32x16_bf16 v[32:47], a[12:15], a[180:183], v[32:47]
  ds_read_b128 a[32:35], v146 offset:20480
  ds_read_b128 a[36:39], v146 offset:8192
  s_waitcnt vmcnt(9) lgkmcnt(4)
  v_mfma_f32_32x32x16_bf16 v[16:31], a[16:19], a[184:187], v[16:31]
  s_add_u32 s92, s92, 4096
  buffer_load_dwordx4 a[224:227], v116, s[68:71], s92 offen offset:0 sc1
  v_mfma_f32_32x32x16_bf16 v[32:47], a[20:23], a[184:187], v[32:47]
  ds_read_b128 a[40:43], v147 offset:20480
  ds_read_b128 a[44:47], v147 offset:8192
  s_waitcnt vmcnt(9) lgkmcnt(4)
  v_mfma_f32_32x32x16_bf16 v[16:31], a[24:27], a[188:191], v[16:31]
  buffer_load_dwordx4 a[228:231], v116, s[68:71], s92 offen offset:1024 sc1
  v_mfma_f32_32x32x16_bf16 v[32:47], a[28:31], a[188:191], v[32:47]
  ds_read_b128 a[48:51], v146 offset:12288
  ds_read_b128 a[52:55], v146 offset:0
  s_waitcnt vmcnt(9) lgkmcnt(4)
  v_mfma_f32_32x32x16_bf16 v[16:31], a[32:35], a[192:195], v[16:31]
  buffer_load_dwordx4 a[232:235], v116, s[68:71], s92 offen offset:2048 sc1
  v_mfma_f32_32x32x16_bf16 v[32:47], a[36:39], a[192:195], v[32:47]
  ds_read_b128 a[56:59], v147 offset:12288
  ds_read_b128 a[60:63], v147 offset:0
  s_waitcnt vmcnt(9) lgkmcnt(4)
  v_mfma_f32_32x32x16_bf16 v[16:31], a[40:43], a[196:199], v[16:31]
  buffer_load_dwordx4 a[236:239], v116, s[68:71], s92 offen offset:3072 sc1
  v_mfma_f32_32x32x16_bf16 v[32:47], a[44:47], a[196:199], v[32:47]
  ds_read_b128 a[64:67], v144 offset:4096
  ds_read_b128 a[68:71], v148 offset:0
  s_waitcnt vmcnt(9) lgkmcnt(4)
  v_mfma_f32_32x32x16_bf16 v[16:31], a[48:51], a[200:203], v[16:31]
  s_lshl_b32 s92, s76, 14
  s_add_u32 s92, s92, 88064
  buffer_load_dwordx4 a[160:163], v117, s[68:71], s92 offen offset:0 sc1
  v_mfma_f32_32x32x16_bf16 v[32:47], a[52:55], a[200:203], v[32:47]
  ds_read_b128 a[72:75], v145 offset:4096
  ds_read_b128 a[76:79], v149 offset:0
  s_waitcnt vmcnt(9) lgkmcnt(4)
  v_mfma_f32_32x32x16_bf16 v[16:31], a[56:59], a[204:207], v[16:31]
  buffer_load_dwordx4 a[164:167], v117, s[68:71], s92 offen offset:1024 sc1
  v_mfma_f32_32x32x16_bf16 v[32:47], a[60:63], a[204:207], v[32:47]
  ds_read_b128 a[80:83], v148 offset:16384
  ds_read_b128 a[84:87], v148 offset:32768
  s_waitcnt vmcnt(9) lgkmcnt(4)
  v_mfma_f32_32x32x16_bf16 v[16:31], a[64:67], a[208:211], v[16:31]
  buffer_load_dwordx4 a[168:171], v117, s[68:71], s92 offen offset:2048 sc1
  v_mfma_f32_32x32x16_bf16 v[32:47], a[68:71], a[208:211], v[32:47]
  ds_read_b128 a[88:91], v149 offset:16384
  ds_read_b128 a[92:95], v149 offset:32768
  s_waitcnt vmcnt(9) lgkmcnt(4)
  v_mfma_f32_32x32x16_bf16 v[16:31], a[72:75], a[212:215], v[16:31]
  buffer_load_dwordx4 a[172:175], v117, s[68:71], s92 offen offset:3072 sc1
  v_mfma_f32_32x32x16_bf16 v[32:47], a[76:79], a[212:215], v[32:47]
  ds_read_b128 a[96:99], v146 offset:4096
  ds_read_b128 a[100:103], v150 offset:0
  s_waitcnt vmcnt(9) lgkmcnt(4)
  v_mfma_f32_32x32x16_bf16 v[16:31], a[80:83], a[216:219], v[16:31]
  s_add_u32 s92, s92, 4096
  buffer_load_dwordx4 a[176:179], v117, s[68:71], s92 offen offset:0 sc1
  v_mfma_f32_32x32x16_bf16 v[32:47], a[84:87], a[216:219], v[32:47]
  ds_read_b128 a[104:107], v147 offset:4096
  ds_read_b128 a[108:111], v151 offset:0
  s_waitcnt vmcnt(9) lgkmcnt(4)
  v_mfma_f32_32x32x16_bf16 v[16:31], a[88:91], a[220:223], v[16:31]
  buffer_load_dwordx4 a[180:183], v117, s[68:71], s92 offen offset:1024 sc1
  v_mfma_f32_32x32x16_bf16 v[32:47], a[92:95], a[220:223], v[32:47]
  ds_read_b128 a[112:115], v150 offset:16384
  ds_read_b128 a[116:119], v150 offset:32768
  s_waitcnt vmcnt(9) lgkmcnt(4)
  v_mfma_f32_32x32x16_bf16 v[16:31], a[96:99], a[224:227], v[16:31]
  v_mfma_f32_32x32x16_bf16 v[32:47], a[100:103], a[224:227], v[32:47]
  ds_read_b128 a[120:123], v151 offset:16384
  ds_read_b128 a[124:127], v151 offset:32768
  s_waitcnt vmcnt(8) lgkmcnt(4)
  v_mfma_f32_32x32x16_bf16 v[16:31], a[104:107], a[228:231], v[16:31]
  buffer_load_dwordx4 a[184:187], v117, s[68:71], s92 offen offset:2048 sc1
  v_mfma_f32_32x32x16_bf16 v[32:47], a[108:111], a[228:231], v[32:47]
  s_waitcnt vmcnt(8) lgkmcnt(2)
  v_mfma_f32_32x32x16_bf16 v[16:31], a[112:115], a[232:235], v[16:31]
  buffer_load_dwordx4 a[188:191], v117, s[68:71], s92 offen offset:3072 sc1
  v_mfma_f32_32x32x16_bf16 v[32:47], a[116:119], a[232:235], v[32:47]
  s_waitcnt vmcnt(8) lgkmcnt(0)
  v_mfma_f32_32x32x16_bf16 v[16:31], a[120:123], a[236:239], v[16:31]
  s_add_u32 s92, s92, 4096
  buffer_load_dwordx4 a[192:195], v117, s[68:71], s92 offen offset:0 sc1
  v_mfma_f32_32x32x16_bf16 v[32:47], a[124:127], a[236:239], v[32:47]
  s_waitcnt vmcnt(8)
  v_mfma_f32_32x32x16_bf16 v[48:63], a[0:3], a[160:163], v[48:63]
  buffer_load_dwordx4 a[196:199], v117, s[68:71], s92 offen offset:1024 sc1
  v_mfma_f32_32x32x16_bf16 v[64:79], a[4:7], a[160:163], v[64:79]
  s_waitcnt vmcnt(8)
  v_mfma_f32_32x32x16_bf16 v[48:63], a[8:11], a[164:167], v[48:63]
  buffer_load_dwordx4 a[200:203], v117, s[68:71], s92 offen offset:2048 sc1
  s_nop 1
  ds_write_b128 v112, v[16:19] offset:0
  v_mfma_f32_32x32x16_bf16 v[64:79], a[12:15], a[164:167], v[64:79]
  ds_write_b128 v113, v[20:23] offset:0
  s_waitcnt vmcnt(8)
  v_mfma_f32_32x32x16_bf16 v[48:63], a[16:19], a[168:171], v[48:63]
  buffer_load_dwordx4 a[204:207], v117, s[68:71], s92 offen offset:3072 sc1
  ds_write_b128 v114, v[24:27] offset:0
  v_mfma_f32_32x32x16_bf16 v[64:79], a[20:23], a[168:171], v[64:79]
  ds_write_b128 v115, v[28:31] offset:0
  s_waitcnt vmcnt(8)
  v_mfma_f32_32x32x16_bf16 v[48:63], a[24:27], a[172:175], v[48:63]
  s_add_u32 s92, s92, 4096
  buffer_load_dwordx4 a[208:211], v117, s[68:71], s92 offen offset:0 sc1
  ds_write_b128 v112, v[32:35] offset:128
  v_mfma_f32_32x32x16_bf16 v[64:79], a[28:31], a[172:175], v[64:79]
  ds_write_b128 v113, v[36:39] offset:128
  s_waitcnt vmcnt(8)
  v_mfma_f32_32x32x16_bf16 v[48:63], a[32:35], a[176:179], v[48:63]
  buffer_load_dwordx4 a[212:215], v117, s[68:71], s92 offen offset:1024 sc1
  ds_write_b128 v114, v[40:43] offset:128
  v_mfma_f32_32x32x16_bf16 v[64:79], a[36:39], a[176:179], v[64:79]
  ds_write_b128 v115, v[44:47] offset:128
  s_waitcnt vmcnt(8)
  v_mfma_f32_32x32x16_bf16 v[48:63], a[40:43], a[180:183], v[48:63]
  buffer_load_dwordx4 a[216:219], v117, s[68:71], s92 offen offset:2048 sc1
  v_mfma_f32_32x32x16_bf16 v[64:79], a[44:47], a[180:183], v[64:79]
  s_waitcnt vmcnt(8)
  s_waitcnt lgkmcnt(0)
  s_barrier
  v_mfma_f32_32x32x16_bf16 v[48:63], a[48:51], a[184:187], v[48:63]
  buffer_load_dwordx4 a[220:223], v117, s[68:71], s92 offen offset:3072 sc1
  ds_read_b128 v[200:203], v102 offset:0
  ds_read_b128 v[204:207], v102 offset:24576
  ds_read_b128 v[208:211], v102 offset:49152
  ds_read_b128 v[212:215], v104 offset:0
  v_mfma_f32_32x32x16_bf16 v[64:79], a[52:55], a[184:187], v[64:79]
  ds_read_b128 v[216:219], v103 offset:0
  ds_read_b128 v[220:223], v103 offset:24576
  ds_read_b128 v[224:227], v103 offset:49152
  ds_read_b128 v[228:231], v105 offset:0
  s_waitcnt vmcnt(8)
  v_mfma_f32_32x32x16_bf16 v[48:63], a[56:59], a[188:191], v[48:63]
  s_waitcnt lgkmcnt(4)
  v_add_f32 v200, v200, v204
  v_add_f32 v201, v201, v205
  v_add_f32 v202, v202, v206
  v_mfma_f32_32x32x16_bf16 v[64:79], a[60:63], a[188:191], v[64:79]
  v_add_f32 v203, v203, v207
  v_add_f32 v208, v208, v212
  v_add_f32 v209, v209, v213
  v_add_f32_e64 v210, v210, v214
  s_waitcnt vmcnt(7)
  v_mfma_f32_32x32x16_bf16 v[48:63], a[64:67], a[192:195], v[48:63]
  v_add_f32 v211, v211, v215
  v_add_f32 v80, v80, v200
  v_add_f32 v81, v81, v201
  v_add_f32 v82, v82, v202
  v_mfma_f32_32x32x16_bf16 v[64:79], a[68:71], a[192:195], v[64:79]
  v_add_f32 v83, v83, v203
  v_add_f32 v80, v80, v208
  v_add_f32 v81, v81, v209
  v_add_f32_e64 v82, v82, v210
  s_waitcnt vmcnt(6)
  v_mfma_f32_32x32x16_bf16 v[48:63], a[72:75], a[196:199], v[48:63]
  v_add_f32 v83, v83, v211
  s_mov_b32 s93, 0
  buffer_store_dwordx4 v[80:83], v96, s[72:75], s93 offen sc1
  s_waitcnt lgkmcnt(0)
  v_mfma_f32_32x32x16_bf16 v[64:79], a[76:79], a[196:199], v[64:79]
  v_add_f32 v216, v216, v220
  v_add_f32 v217, v217, v221
  v_add_f32 v218, v218, v222
  v_add_f32 v219, v219, v223
  s_waitcnt vmcnt(6)
  v_mfma_f32_32x32x16_bf16 v[48:63], a[80:83], a[200:203], v[48:63]
  v_add_f32 v224, v224, v228
  v_add_f32 v225, v225, v229
  v_add_f32 v226, v226, v230
  v_add_f32 v227, v227, v231
  v_add_f32 v84, v84, v216
  s_waitcnt vmcnt(5)
  v_mfma_f32_32x32x16_bf16 v[48:63], a[88:91], a[204:207], v[48:63]
  v_add_f32 v85, v85, v217
  v_add_f32 v86, v86, v218
  v_add_f32 v87, v87, v219
  v_add_f32 v84, v84, v224
  v_add_f32 v85, v85, v225
  s_waitcnt vmcnt(4)
  v_mfma_f32_32x32x16_bf16 v[48:63], a[96:99], a[208:211], v[48:63]
  v_add_f32 v86, v86, v226
  v_add_f32 v87, v87, v227
  s_mov_b32 s93, 32768
  buffer_store_dwordx4 v[84:87], v96, s[72:75], s93 offen sc1
  s_waitcnt vmcnt(4)
  v_mfma_f32_32x32x16_bf16 v[48:63], a[104:107], a[212:215], v[48:63]
  s_waitcnt vmcnt(3)
  v_mfma_f32_32x32x16_bf16 v[48:63], a[112:115], a[216:219], v[48:63]
  s_waitcnt vmcnt(2)
  v_mfma_f32_32x32x16_bf16 v[48:63], a[120:123], a[220:223], v[48:63]
  v_mfma_f32_32x32x16_bf16 v[64:79], a[84:87], a[200:203], v[64:79]
  v_mfma_f32_32x32x16_bf16 v[64:79], a[92:95], a[204:207], v[64:79]
  v_mfma_f32_32x32x16_bf16 v[64:79], a[100:103], a[208:211], v[64:79]
  s_nop 8
  ds_write_b128 v112, v[48:51] offset:8192
  v_mfma_f32_32x32x16_bf16 v[64:79], a[108:111], a[212:215], v[64:79]
  ds_write_b128 v113, v[52:55] offset:8192
  v_mfma_f32_32x32x16_bf16 v[64:79], a[116:119], a[216:219], v[64:79]
  ds_write_b128 v114, v[56:59] offset:8192
  v_mfma_f32_32x32x16_bf16 v[64:79], a[124:127], a[220:223], v[64:79]
  ds_write_b128 v115, v[60:63] offset:8192
  s_nop 10
  ds_write_b128 v112, v[64:67] offset:8320
  ds_write_b128 v113, v[68:71] offset:8320
  ds_write_b128 v114, v[72:75] offset:8320
  ds_write_b128 v115, v[76:79] offset:8320
  s_waitcnt lgkmcnt(0)
  s_barrier
  ds_read_b128 v[16:19], v102 offset:8192
  ds_read_b128 v[20:23], v102 offset:32768
  ds_read_b128 v[24:27], v102 offset:57344
  ds_read_b128 v[28:31], v104 offset:8192
  ds_read_b128 v[32:35], v103 offset:8192
  ds_read_b128 v[36:39], v103 offset:32768
  ds_read_b128 v[40:43], v103 offset:57344
  ds_read_b128 v[44:47], v105 offset:8192
  s_waitcnt lgkmcnt(4)
  v_pk_add_f32 v[16:17], v[16:17], v[20:21]
  v_pk_add_f32 v[18:19], v[18:19], v[22:23]
  v_pk_add_f32 v[24:25], v[24:25], v[28:29]
  v_pk_add_f32 v[26:27], v[26:27], v[30:31]
  v_pk_add_f32 v[88:89], v[88:89], v[16:17]
  v_pk_add_f32 v[90:91], v[90:91], v[18:19]
  v_pk_add_f32 v[88:89], v[88:89], v[24:25]
  v_pk_add_f32 v[90:91], v[90:91], v[26:27]
  s_mov_b32 s93, 65536
  buffer_store_dwordx4 v[88:91], v96, s[72:75], s93 offen sc1
  s_waitcnt lgkmcnt(0)
  v_pk_add_f32 v[32:33], v[32:33], v[36:37]
  v_pk_add_f32 v[34:35], v[34:35], v[38:39]
  v_pk_add_f32 v[40:41], v[40:41], v[44:45]
  v_pk_add_f32 v[42:43], v[42:43], v[46:47]
  v_pk_add_f32 v[92:93], v[92:93], v[32:33]
  v_pk_add_f32 v[94:95], v[94:95], v[34:35]
  v_pk_add_f32 v[92:93], v[92:93], v[40:41]
  v_pk_add_f32 v[94:95], v[94:95], v[42:43]
  s_mov_b32 s93, 98304
  buffer_store_dwordx4 v[92:95], v96, s[72:75], s93 offen sc1
L_end:
  s_endpgm
.section .rodata,"a"
.p2align 6
.amdhsa_kernel parallel_sum__ssm_conv_s5__dense_activation_squared_relu__prompt_kernel
  .amdhsa_next_free_vgpr 512
  .amdhsa_next_free_sgpr 102
  .amdhsa_accum_offset 256
  .amdhsa_group_segment_fixed_size 0
  .amdhsa_kernarg_size 136
  .amdhsa_user_sgpr_count 2
  .amdhsa_user_sgpr_kernarg_segment_ptr 1
  .amdhsa_system_sgpr_workgroup_id_x 1
.end_amdhsa_kernel
```
